```python
import torch

def _softmax(x, axis=-1):
    return torch.softmax(x, dim=axis)
def _gelu(x):
    return torch.nn.functional.gelu(x, approximate="tanh")
def _silu(x):
    return torch.nn.functional.silu(x)
def _sigmoid(x):
    return torch.sigmoid(x)
def _layernorm(x, axis=-1, eps=1e-5):
    m = x.mean(dim=axis, keepdim=True)
    v = x.var(dim=axis, keepdim=True, unbiased=False)
    return (x - m) / torch.sqrt(v + eps)
def _scatter_add(tgt, idx, src, axis=0):
    return tgt.clone().index_add_(axis, idx, src)
def _segment_sum(src, seg, n):
    out = torch.zeros((n,) + src.shape[1:], dtype=src.dtype)
    return out.index_add_(0, seg, src)
def _pad(x, pw):
    flat = tuple(v for pair in reversed(pw) for v in pair)
    return torch.nn.functional.pad(x, flat)

kernel_name = 'parallel_sum__sliding_block__glu_gated_bilinear__prompt'

def setup_inputs():

    _w = (lambda a: (lambda t: t.to(torch.bfloat16) if t.is_floating_point() else t)(torch.as_tensor(a)))
    def _A_setup():
        B, S, D = 1, 2048, 640
        return {
            "x": _w((lambda *s: torch.randn(*s, dtype=torch.bfloat16) * 0.05)(B, S, D)),
            "wqkv": _w((lambda *s: torch.randn(*s, dtype=torch.bfloat16) * 0.05)(D, 3 * D)),
            "wo": _w((lambda *s: torch.randn(*s, dtype=torch.bfloat16) * 0.05)(D, D)),
        }
    _A_in = _A_setup()

    def _B_setup():
        B, S, D, F = 1, 2048, 640, 1536
        return {
            "x": _w((lambda *s: torch.randn(*s, dtype=torch.bfloat16) * 0.05)(B, S, D)),
            "w_gate": _w((lambda *s: torch.randn(*s, dtype=torch.bfloat16) * 0.8)(D, F) * (D ** -0.5)),
            "w_up": _w((lambda *s: torch.randn(*s, dtype=torch.bfloat16) * 0.8)(D, F) * (D ** -0.5)),
            "w_down": _w((lambda *s: torch.randn(*s, dtype=torch.bfloat16) * 0.8)(F, D) * (F ** -0.5)),
        }
    _B_in = _B_setup()

    return {
        "A_x": _A_in["x"],
        "A_wqkv": _A_in["wqkv"],
        "A_wo": _A_in["wo"],
        "B_x": _B_in["x"],
        "B_w_gate": _B_in["w_gate"],
        "B_w_up": _B_in["w_up"],
        "B_w_down": _B_in["w_down"],
    }

def reference(A_x, A_wqkv, A_wo, B_x, B_w_gate, B_w_up, B_w_down):
    def _A_ref(x, wqkv, wo):
        B, S, D = x.shape
        H = 32; Dh = D // H; W = 256
        qkv = (lambda x, *d: x.permute(*d))((x @ wqkv).reshape(B, S, 3, H, Dh), 2, 0, 3, 1, 4)
        q, k, v = qkv[0], qkv[1], qkv[2]
        scores = torch.einsum("bhqd,bhkd->bhqk", q, k) * (Dh ** -0.5)
        idx = torch.arange(S)
        mask = (idx[:, None] - idx[None, :] >= 0) & (idx[:, None] - idx[None, :] < W)
        scores = torch.where(mask[None, None], scores, -1e9)
        p = _softmax(scores, axis=-1)
        o = torch.einsum("bhqk,bhkd->bhqd", p, v)
        return (lambda x, *d: x.permute(*d))(o, 0, 2, 1, 3).reshape(B, S, D) @ wo

    def _B_ref(x, w_gate, w_up, w_down):
        g = torch.einsum("bsd,df->bsf", x, w_gate)
        u = torch.einsum("bsd,df->bsf", x, w_up)
        h = g * u
        return torch.einsum("bsf,fd->bsd", h, w_down)

    x = A_x
    xn = _layernorm(x, axis=-1)
    return x + _A_ref(xn, A_wqkv, A_wo) + _B_ref(xn, B_w_gate, B_w_up, B_w_down)
```

```asm
; @launch kernel=k1_kernel grid=(256,1,1) block=(512,1,1) lds=159744
; @launch kernel=parallel_sum__sliding_block__glu_gated_bilinear__prompt_kernel grid=(256,1,1) block=(512,1,1) lds=82048
.amdgcn_target "amdgcn-amd-amdhsa--gfx950"
.text
.globl k1_kernel
.p2align 8
.type k1_kernel,@function
k1_kernel:
    s_cmp_ge_u32 s2, 256
    s_cbranch_scc1 END_0
    s_load_dwordx4 s[4:7], s[0:1], 0
    s_load_dwordx2 s[8:9], s[0:1], 16
    s_load_dwordx4 s[12:15], s[0:1], 32
    s_load_dwordx2 s[16:17], s[0:1], 48
    s_load_dwordx2 s[18:19], s[0:1], 72
    s_getpc_b64 s[84:85]
PC_A:
    v_lshlrev_b32 v254, 7, v0
    s_sub_u32 s84, s84, PC_A-k1_kernel
    s_subb_u32 s85, s85, 0
    s_mov_b32 s86, CODE_END-k1_kernel
    s_mov_b32 s87, 0x20000
    buffer_load_dword v255, v254, s[84:87], 0 offen
    v_lshrrev_b32 v1, 6, v0
    v_and_b32 v0, 63, v0
    s_nop 0
    v_readfirstlane_b32 s24, v1
    s_and_b32 s46, s2, 7
    s_lshr_b32 s47, s2, 3
    s_and_b32 s27, s46, 1
    s_lshl_b32 s27, s27, 3
    s_and_b32 s33, s47, 7
    s_add_u32 s27, s27, s33
    s_lshr_b32 s28, s46, 1
    s_lshl_b32 s28, s28, 2
    s_lshr_b32 s33, s47, 3
    s_add_u32 s28, s28, s33
    s_and_b32 s25, s24, 3
    s_lshr_b32 s26, s24, 2
    s_lshl_b32 s30, s24, 10
    s_mov_b32 s45, 0x3f803f80
    s_sub_u32 s46, s28, 8
    s_mul_i32 s47, s46, 3
    s_lshl_b32 s33, s28, 1
    s_cmp_ge_u32 s28, 8
    s_cselect_b32 s29, 1, 0
    s_cselect_b32 s34, s47, s33
    s_add_u32 s35, s34, s29
    s_cmp_ge_u32 s28, 6
    s_cselect_b32 s36, 22, 24
    s_add_u32 s36, s36, s28
    s_add_u32 s47, s47, 2
    s_add_u32 s33, s33, 1
    s_add_u32 s46, s46, 16
    s_cmp_ge_u32 s28, 8
    s_cselect_b32 s36, s47, s36
    s_cselect_b32 s37, s46, s33
    s_mov_b32 s46, 3072
    s_mov_b32 s47, 3840
    s_cselect_b32 s32, s47, s46
    v_lshrrev_b32 v2, 3, v0
    s_lshl_b32 s33, s24, 3
    v_add_u32 v2, s33, v2
    v_and_b32 v3, 7, v0
    v_bfe_u32 v4, v2, 1, 3
    v_xor_b32 v4, v4, v3
    v_lshlrev_b32 v4, 4, v4
    s_movk_i32 s33, 1280
    v_mad_u32_u24 v8, v2, s33, v4
    v_bfe_u32 v4, v2, 1, 1
    v_lshlrev_b32 v4, 2, v4
    v_xor_b32 v4, v4, v3
    v_lshlrev_b32 v4, 4, v4
    v_mad_u32_u24 v9, v2, s32, v4
    s_mul_i32 s33, s27, 163840
    s_mul_i32 s38, s32, 639
    s_add_u32 s38, s38, 128
    s_lshl_b32 s32, s32, 6
    s_lshl_b32 s46, s34, 7
    s_lshl_b32 s47, s35, 7
    s_waitcnt lgkmcnt(0)
    s_add_u32 s48, s4, s33
    s_addc_u32 s49, s5, 0
    s_mov_b32 s50, 163840
    s_mov_b32 s51, 0x20000
    s_cmp_eq_u32 s29, 1
    s_cselect_b32 s52, s6, s12
    s_cselect_b32 s53, s7, s13
    s_cselect_b32 s56, s6, s14
    s_cselect_b32 s57, s7, s15
    s_add_u32 s52, s52, s46
    s_addc_u32 s53, s53, 0
    s_mov_b32 s54, s38
    s_mov_b32 s55, 0x20000
    s_add_u32 s56, s56, s47
    s_addc_u32 s57, s57, 0
    s_mov_b32 s58, s38
    s_mov_b32 s59, 0x20000
    s_and_b32 s20, s28, 3
    s_mul_i32 s20, s20, 5
    s_lshr_b32 s20, s20, 1
    s_and_b32 s21, s27, 7
    s_add_u32 s20, s20, s21
    s_sub_u32 s21, s20, 10
    s_cmp_ge_u32 s20, 10
    s_cselect_b32 s20, s21, s20
    s_mul_i32 s31, s20, s32
    s_mul_i32 s23, s32, 10
    s_mul_i32 s21, s20, 245760
    s_mul_i32 s22, s20, 196608
    s_lshl_b32 s20, s20, 7
    s_add_u32 m0, s30, 0
    s_add_u32 s33, s20, 0
    buffer_load_dwordx4 v8, s[48:51], s33 offen lds
    s_add_u32 m0, s30, 8192
    s_add_u32 s33, s20, 81920
    buffer_load_dwordx4 v8, s[48:51], s33 offen lds
    s_add_u32 s20, s20, 128
    s_cmp_eq_u32 s20, 1280
    s_cselect_b32 s20, 0, s20
    s_add_u32 m0, s30, 16384
    s_nop 0
    buffer_load_dwordx4 v9, s[52:55], s31 offen lds
    s_add_u32 m0, s30, 24576
    s_nop 0
    buffer_load_dwordx4 v9, s[56:59], s31 offen lds
    s_add_u32 s31, s31, s32
    s_cmp_eq_u32 s31, s23
    s_cselect_b32 s31, 0, s31
    s_add_u32 m0, s30, 32768
    s_add_u32 s33, s20, 0
    buffer_load_dwordx4 v8, s[48:51], s33 offen lds
    s_add_u32 m0, s30, 40960
    s_add_u32 s33, s20, 81920
    buffer_load_dwordx4 v8, s[48:51], s33 offen lds
    s_add_u32 s20, s20, 128
    s_cmp_eq_u32 s20, 1280
    s_cselect_b32 s20, 0, s20
    s_add_u32 m0, s30, 49152
    s_nop 0
    buffer_load_dwordx4 v9, s[52:55], s31 offen lds
    s_add_u32 m0, s30, 57344
    s_nop 0
    buffer_load_dwordx4 v9, s[56:59], s31 offen lds
    s_add_u32 s31, s31, s32
    s_cmp_eq_u32 s31, s23
    s_cselect_b32 s31, 0, s31
    s_cmp_eq_u32 s26, 0
    s_cselect_b64 vcc, 0, -1
    s_lshl_b32 s46, s36, 7
    s_add_u32 s60, s6, s46
    s_addc_u32 s61, s7, 0
    s_mov_b32 s62, 2453888
    s_mov_b32 s63, 0x20000
    s_lshl_b32 s46, s37, 7
    s_add_u32 s64, s12, s46
    s_addc_u32 s65, s13, 0
    s_mov_b32 s66, 1963136
    s_mov_b32 s67, 0x20000
    s_add_u32 s68, s14, s46
    s_addc_u32 s69, s15, 0
    s_mov_b32 s70, 1963136
    s_mov_b32 s71, 0x20000
    s_lshr_b32 s46, s28, 1
    s_cmp_eq_u32 s46, 3
    s_cselect_b64 s[96:97], 0, -1
    s_mov_b32 s72, s18
    s_mov_b32 s73, s19
    s_mov_b32 s74, 7864320
    s_mov_b32 s75, 0x20000
    s_add_u32 s76, s18, 8388608
    s_addc_u32 s77, s19, 0
    s_mov_b32 s78, 8912896
    s_mov_b32 s79, 0x20000
    s_lshl_b32 s38, s34, 12
    s_lshl_b32 s39, s35, 12
    s_lshl_b32 s40, s36, 12
    s_lshl_b32 s41, s37, 12
    s_mov_b32 s46, 0x3ea52b5c
    s_cmp_lt_u32 s34, 10
    s_cselect_b32 s42, s46, 1.0
    s_cmp_lt_u32 s35, 10
    s_cselect_b32 s43, s46, 1.0
    s_cmp_lt_u32 s36, 10
    s_cselect_b32 s44, s46, 1.0
    v_lshrrev_b32 v12, 5, v0
    v_bfe_u32 v13, v0, 2, 2
    v_lshl_add_u32 v1, v12, 3, v13
    v_lshlrev_b32 v1, 7, v1
    v_lshrrev_b32 v13, 1, v13
    v_xor_b32 v13, s26, v13
    v_lshl_add_u32 v1, v13, 6, v1
    v_bfe_u32 v13, v0, 4, 1
    v_lshl_add_u32 v1, v13, 5, v1
    v_and_b32 v13, 3, v0
    v_lshl_add_u32 v1, v13, 3, v1
    s_lshl_b32 s46, s26, 1
    s_xor_b32 s93, s46, s25
    s_lshl_b32 s46, s93, 11
    v_add_u32 v1, s46, v1
    v_xor_b32 v2, 0x800, v1
    v_xor_b32 v3, 0x1000, v1
    v_xor_b32 v25, 0x1800, v1
    v_and_b32 v31, 31, v0
    v_bfe_u32 v13, v0, 1, 3
    v_xor_b32 v13, v13, v12
    v_lshlrev_b32 v13, 4, v13
    s_lshl_b32 s46, s25, 12
    v_lshl_add_u32 v4, v31, 7, v13
    v_add_u32 v4, s46, v4
    s_lshl_b32 s46, s93, 5
    v_xor_b32 v4, s46, v4
    v_xor_b32 v5, 32, v4
    v_xor_b32 v6, 64, v4
    v_xor_b32 v7, 96, v4
    s_lshl_b32 s46, s27, 2
    s_add_u32 s46, s46, s25
    s_mul_i32 s47, s46, 122880
    s_lshl_b32 s33, s26, 11
    s_add_u32 s47, s47, s33
    v_lshlrev_b32 v26, 3, v31
    v_lshl_add_u32 v26, v12, 8, v26
    v_add_u32 v26, s47, v26
    s_mul_i32 s47, s46, 139264
    s_add_u32 s47, s47, s33
    v_lshlrev_b32 v27, 4, v31
    v_lshl_add_u32 v27, v12, 9, v27
    v_add_u32 v27, s47, v27
    v_mov_b32 v10, 0
    v_mov_b32 v11, 0
    v_lshrrev_b32 v16, 4, v0
    v_xor_b32 v16, v16, v0
    v_and_b32 v16, 1, v16
    v_subrev_u32 v16, 1, v16
    v_and_b32 v16, s45, v16
    v_mov_b32 v17, v16
    v_mov_b32 v18, v16
    v_mov_b32 v19, v16
    s_mov_b32 s45, 0x3f803f80
    s_mov_b32 s93, 0xffff0000
    s_lshl_b32 s46, s24, 8
    s_add_u32 s46, s46, s2
    s_mul_i32 s47, s46, 6554
    s_lshr_b32 s47, s47, 16
    s_mul_i32 s33, s47, 10
    s_sub_u32 s33, s46, s33
    s_mul_i32 s88, s47, 40
    s_lshl_b32 s89, s33, 2
    s_add_u32 s88, s88, s89
    s_lshl_b32 s88, s88, 10
    s_lshl_b32 s33, s33, 7
    s_sub_u32 s89, s47, 48
    s_cmp_ge_u32 s47, 48
    s_cselect_b32 s47, s89, s47
    s_cselect_b32 s80, s8, s16
    s_cselect_b32 s81, s9, s17
    s_cselect_b32 s90, 8, 4
    s_cselect_b32 s91, 4, 8
    s_lshl_b32 s91, s91, 7
    s_mul_i32 s47, s47, 40960
    s_add_u32 s47, s47, s33
    s_add_u32 s80, s80, s47
    s_addc_u32 s81, s81, 0
    s_mov_b32 s82, 39808
    s_mov_b32 s83, 0x20000
    s_mov_b32 s89, s46
    s_lshl_b32 s33, s24, 12
    s_add_u32 s92, s33, 131072
    s_lshl_b32 s46, s26, 10
    s_add_u32 s46, s46, 147456
    v_and_b32 v31, 31, v0
    v_lshl_add_u32 v31, v31, 4, s46
    s_lshl_b32 s3, s25, 2
    s_add_u32 s3, s3, s46
    s_lshl_b32 s10, s25, 10
    s_add_u32 s10, s10, 153600
    s_lshl_b32 s11, s26, 9
    s_add_u32 s84, s18, 18874368
    s_addc_u32 s85, s19, 0
    s_mov_b32 s86, 2785280
    s_mov_b32 s87, 0x20000
    s_waitcnt lgkmcnt(0)
    s_waitcnt vmcnt(4)
    s_barrier
    ds_read_b128 v[96:99], v4 offset:0
    ds_read_b64_tr_b16 v[32:33], v1 offset:16384
    ds_read_b64_tr_b16 v[34:35], v1 offset:16896
    ds_read_b64_tr_b16 v[36:37], v1 offset:24576
    ds_read_b64_tr_b16 v[38:39], v1 offset:25088
    s_add_u32 m0, s30, 65536
    s_add_u32 s33, s20, 0
    buffer_load_dwordx4 v8, s[48:51], s33 offen lds
    s_add_u32 m0, s30, 73728
    s_add_u32 s33, s20, 81920
    buffer_load_dwordx4 v8, s[48:51], s33 offen lds
    s_add_u32 s20, s20, 128
    s_cmp_eq_u32 s20, 1280
    s_cselect_b32 s20, 0, s20
    ds_read_b128 v[100:103], v5 offset:0
    ds_read_b64_tr_b16 v[40:41], v2 offset:16384
    ds_read_b64_tr_b16 v[42:43], v2 offset:16896
    ds_read_b64_tr_b16 v[44:45], v2 offset:24576
    ds_read_b64_tr_b16 v[46:47], v2 offset:25088
    s_add_u32 m0, s30, 81920
    s_nop 0
    buffer_load_dwordx4 v9, s[52:55], s31 offen lds
    s_add_u32 m0, s30, 90112
    s_nop 0
    buffer_load_dwordx4 v9, s[56:59], s31 offen lds
    s_add_u32 s31, s31, s32
    s_cmp_eq_u32 s31, s23
    s_cselect_b32 s31, 0, s31
    s_waitcnt lgkmcnt(9)
    s_waitcnt lgkmcnt(7)
    v_mfma_f32_32x32x16_bf16 v[48:63], v[32:35], v[96:99], 0
    v_mfma_f32_16x16x32_bf16 v[20:23], v[32:35], v[16:19], 0
    ds_read_b128 v[104:107], v6 offset:0
    ds_read_b64_tr_b16 v[32:33], v3 offset:16384
    ds_read_b64_tr_b16 v[34:35], v3 offset:16896
    s_waitcnt lgkmcnt(8)
    v_mfma_f32_32x32x16_bf16 v[64:79], v[36:39], v[96:99], 0
    ds_read_b64_tr_b16 v[36:37], v3 offset:24576
    ds_read_b64_tr_b16 v[38:39], v3 offset:25088
    s_add_u32 m0, s30, 98304
    s_add_u32 s33, s20, 0
    buffer_load_dwordx4 v8, s[48:51], s33 offen lds
    s_add_u32 m0, s30, 106496
    s_add_u32 s33, s20, 81920
    buffer_load_dwordx4 v8, s[48:51], s33 offen lds
    s_add_u32 s20, s20, 128
    s_cmp_eq_u32 s20, 1280
    s_cselect_b32 s20, 0, s20
    s_waitcnt lgkmcnt(9)
    s_waitcnt lgkmcnt(7)
    v_mfma_f32_32x32x16_bf16 v[48:63], v[40:43], v[100:103], v[48:63]
    ds_read_b128 v[108:111], v7 offset:0
    ds_read_b64_tr_b16 v[40:41], v25 offset:16384
    ds_read_b64_tr_b16 v[42:43], v25 offset:16896
    s_waitcnt lgkmcnt(8)
    v_mfma_f32_32x32x16_bf16 v[64:79], v[44:47], v[100:103], v[64:79]
    ds_read_b64_tr_b16 v[44:45], v25 offset:24576
    ds_read_b64_tr_b16 v[46:47], v25 offset:25088
    s_add_u32 m0, s30, 114688
    s_nop 0
    buffer_load_dwordx4 v9, s[52:55], s31 offen lds
    s_add_u32 m0, s30, 122880
    s_nop 0
    buffer_load_dwordx4 v9, s[56:59], s31 offen lds
    s_add_u32 s31, s31, s32
    s_cmp_eq_u32 s31, s23
    s_cselect_b32 s31, 0, s31
    s_waitcnt lgkmcnt(9)
    s_waitcnt lgkmcnt(7)
    v_mfma_f32_32x32x16_bf16 v[48:63], v[32:35], v[104:107], v[48:63]
    v_dot2c_f32_bf16 v10, s45, v96
    v_dot2c_f32_bf16 v11, v96, v96
    v_dot2c_f32_bf16 v10, s45, v97
    v_dot2c_f32_bf16 v11, v97, v97
    v_dot2c_f32_bf16 v10, s45, v98
    v_dot2c_f32_bf16 v11, v98, v98
    v_dot2c_f32_bf16 v10, s45, v99
    v_dot2c_f32_bf16 v11, v99, v99
    v_dot2c_f32_bf16 v10, s45, v100
    v_dot2c_f32_bf16 v11, v100, v100
    v_dot2c_f32_bf16 v10, s45, v101
    v_dot2c_f32_bf16 v11, v101, v101
    v_dot2c_f32_bf16 v10, s45, v102
    v_dot2c_f32_bf16 v11, v102, v102
    v_dot2c_f32_bf16 v10, s45, v103
    v_dot2c_f32_bf16 v11, v103, v103
    s_waitcnt lgkmcnt(0)
    s_waitcnt vmcnt(8)
    s_barrier
    ds_read_b128 v[112:115], v4 offset:32768
    ds_read_b64_tr_b16 v[32:33], v1 offset:49152
    ds_read_b64_tr_b16 v[34:35], v1 offset:49664
    v_mfma_f32_32x32x16_bf16 v[64:79], v[36:39], v[104:107], v[64:79]
    v_mfma_f32_16x16x32_bf16 v[12:15], v[36:39], v[16:19], 0
    ds_read_b64_tr_b16 v[36:37], v1 offset:57344
    ds_read_b64_tr_b16 v[38:39], v1 offset:57856
    s_add_u32 m0, s30, 131072
    s_add_u32 s33, s20, 0
    buffer_load_dwordx4 v8, s[48:51], s33 offen lds
    s_add_u32 m0, s30, 139264
    s_add_u32 s33, s20, 81920
    buffer_load_dwordx4 v8, s[48:51], s33 offen lds
    s_add_u32 s20, s20, 128
    s_cmp_eq_u32 s20, 1280
    s_cselect_b32 s20, 0, s20
    v_mfma_f32_32x32x16_bf16 v[48:63], v[40:43], v[108:111], v[48:63]
    ds_read_b128 v[116:119], v5 offset:32768
    ds_read_b64_tr_b16 v[40:41], v2 offset:49152
    ds_read_b64_tr_b16 v[42:43], v2 offset:49664
    v_mfma_f32_32x32x16_bf16 v[64:79], v[44:47], v[108:111], v[64:79]
    ds_read_b64_tr_b16 v[44:45], v2 offset:57344
    ds_read_b64_tr_b16 v[46:47], v2 offset:57856
    s_add_u32 m0, s30, 0
    s_nop 0
    buffer_load_dwordx4 v9, s[52:55], s31 offen lds
    s_add_u32 m0, s30, 8192
    s_nop 0
    buffer_load_dwordx4 v9, s[56:59], s31 offen lds
    s_add_u32 s31, s31, s32
    s_cmp_eq_u32 s31, s23
    s_cselect_b32 s31, 0, s31
    s_waitcnt lgkmcnt(9)
    s_waitcnt lgkmcnt(7)
    v_mfma_f32_32x32x16_bf16 v[48:63], v[32:35], v[112:115], v[48:63]
    v_mfma_f32_16x16x32_bf16 v[20:23], v[32:35], v[16:19], v[20:23]
    ds_read_b128 v[120:123], v6 offset:32768
    ds_read_b64_tr_b16 v[32:33], v3 offset:49152
    ds_read_b64_tr_b16 v[34:35], v3 offset:49664
    s_waitcnt lgkmcnt(8)
    v_mfma_f32_32x32x16_bf16 v[64:79], v[36:39], v[112:115], v[64:79]
    ds_read_b64_tr_b16 v[36:37], v3 offset:57344
    ds_read_b64_tr_b16 v[38:39], v3 offset:57856
    s_add_u32 m0, s30, 16384
    s_add_u32 s33, s20, 0
    buffer_load_dwordx4 v8, s[48:51], s33 offen lds
    s_add_u32 m0, s30, 24576
    s_add_u32 s33, s20, 81920
    buffer_load_dwordx4 v8, s[48:51], s33 offen lds
    s_add_u32 s20, s20, 128
    s_cmp_eq_u32 s20, 1280
    s_cselect_b32 s20, 0, s20
    s_waitcnt lgkmcnt(9)
    s_waitcnt lgkmcnt(7)
    v_mfma_f32_32x32x16_bf16 v[48:63], v[40:43], v[116:119], v[48:63]
    ds_read_b128 v[124:127], v7 offset:32768
    ds_read_b64_tr_b16 v[40:41], v25 offset:49152
    ds_read_b64_tr_b16 v[42:43], v25 offset:49664
    s_waitcnt lgkmcnt(8)
    v_mfma_f32_32x32x16_bf16 v[64:79], v[44:47], v[116:119], v[64:79]
    ds_read_b64_tr_b16 v[44:45], v25 offset:57344
    ds_read_b64_tr_b16 v[46:47], v25 offset:57856
    s_waitcnt lgkmcnt(9)
    s_waitcnt lgkmcnt(7)
    v_mfma_f32_32x32x16_bf16 v[48:63], v[32:35], v[120:123], v[48:63]
    v_dot2c_f32_bf16 v10, s45, v112
    v_dot2c_f32_bf16 v11, v112, v112
    v_dot2c_f32_bf16 v10, s45, v113
    v_dot2c_f32_bf16 v11, v113, v113
    v_dot2c_f32_bf16 v10, s45, v114
    v_dot2c_f32_bf16 v11, v114, v114
    v_dot2c_f32_bf16 v10, s45, v115
    v_dot2c_f32_bf16 v11, v115, v115
    v_dot2c_f32_bf16 v10, s45, v116
    v_dot2c_f32_bf16 v11, v116, v116
    v_dot2c_f32_bf16 v10, s45, v117
    v_dot2c_f32_bf16 v11, v117, v117
    v_dot2c_f32_bf16 v10, s45, v118
    v_dot2c_f32_bf16 v11, v118, v118
    v_dot2c_f32_bf16 v10, s45, v119
    v_dot2c_f32_bf16 v11, v119, v119
    s_waitcnt lgkmcnt(0)
    s_waitcnt vmcnt(10)
    s_barrier
    v_add_u32 v30, 65536, v4
    ds_read_b128 v[128:131], v30
    v_add_u32 v1, 81920, v1
    ds_read_b64_tr_b16 v[32:33], v1 offset:0
    ds_read_b64_tr_b16 v[34:35], v1 offset:512
    v_mfma_f32_32x32x16_bf16 v[64:79], v[36:39], v[120:123], v[64:79]
    v_mfma_f32_16x16x32_bf16 v[12:15], v[36:39], v[16:19], v[12:15]
    ds_read_b64_tr_b16 v[36:37], v1 offset:8192
    ds_read_b64_tr_b16 v[38:39], v1 offset:8704
    s_add_u32 m0, s30, 32768
    s_nop 0
    buffer_load_dwordx4 v9, s[52:55], s31 offen lds
    s_add_u32 m0, s30, 40960
    s_nop 0
    buffer_load_dwordx4 v9, s[56:59], s31 offen lds
    s_add_u32 s31, s31, s32
    s_cmp_eq_u32 s31, s23
    s_cselect_b32 s31, 0, s31
    v_mfma_f32_32x32x16_bf16 v[48:63], v[40:43], v[124:127], v[48:63]
    v_add_u32 v30, 65536, v5
    ds_read_b128 v[132:135], v30
    v_add_u32 v2, 81920, v2
    ds_read_b64_tr_b16 v[40:41], v2 offset:0
    ds_read_b64_tr_b16 v[42:43], v2 offset:512
    v_mfma_f32_32x32x16_bf16 v[64:79], v[44:47], v[124:127], v[64:79]
    ds_read_b64_tr_b16 v[44:45], v2 offset:8192
    ds_read_b64_tr_b16 v[46:47], v2 offset:8704
    s_add_u32 m0, s30, 49152
    s_add_u32 s33, s20, 0
    buffer_load_dwordx4 v8, s[48:51], s33 offen lds
    s_add_u32 m0, s30, 57344
    s_add_u32 s33, s20, 81920
    buffer_load_dwordx4 v8, s[48:51], s33 offen lds
    s_add_u32 s20, s20, 128
    s_cmp_eq_u32 s20, 1280
    s_cselect_b32 s20, 0, s20
    s_waitcnt lgkmcnt(9)
    s_waitcnt lgkmcnt(7)
    v_mfma_f32_32x32x16_bf16 v[48:63], v[32:35], v[128:131], v[48:63]
    v_mfma_f32_16x16x32_bf16 v[20:23], v[32:35], v[16:19], v[20:23]
    v_add_u32 v30, 65536, v6
    ds_read_b128 v[136:139], v30
    v_add_u32 v3, 81920, v3
    ds_read_b64_tr_b16 v[32:33], v3 offset:0
    ds_read_b64_tr_b16 v[34:35], v3 offset:512
    s_waitcnt lgkmcnt(8)
    v_mfma_f32_32x32x16_bf16 v[64:79], v[36:39], v[128:131], v[64:79]
    ds_read_b64_tr_b16 v[36:37], v3 offset:8192
    ds_read_b64_tr_b16 v[38:39], v3 offset:8704
    s_waitcnt lgkmcnt(9)
    s_waitcnt lgkmcnt(7)
    v_mfma_f32_32x32x16_bf16 v[48:63], v[40:43], v[132:135], v[48:63]
    v_add_u32 v30, 65536, v7
    ds_read_b128 v[140:143], v30
    v_add_u32 v25, 81920, v25
    ds_read_b64_tr_b16 v[40:41], v25 offset:0
    ds_read_b64_tr_b16 v[42:43], v25 offset:512
    s_waitcnt lgkmcnt(8)
    v_mfma_f32_32x32x16_bf16 v[64:79], v[44:47], v[132:135], v[64:79]
    ds_read_b64_tr_b16 v[44:45], v25 offset:8192
    ds_read_b64_tr_b16 v[46:47], v25 offset:8704
    s_waitcnt lgkmcnt(9)
    s_waitcnt lgkmcnt(7)
    v_mfma_f32_32x32x16_bf16 v[48:63], v[32:35], v[136:139], v[48:63]
    v_dot2c_f32_bf16 v10, s45, v128
    v_dot2c_f32_bf16 v11, v128, v128
    v_dot2c_f32_bf16 v10, s45, v129
    v_dot2c_f32_bf16 v11, v129, v129
    v_dot2c_f32_bf16 v10, s45, v130
    v_dot2c_f32_bf16 v11, v130, v130
    v_dot2c_f32_bf16 v10, s45, v131
    v_dot2c_f32_bf16 v11, v131, v131
    v_dot2c_f32_bf16 v10, s45, v132
    v_dot2c_f32_bf16 v11, v132, v132
    v_dot2c_f32_bf16 v10, s45, v133
    v_dot2c_f32_bf16 v11, v133, v133
    v_dot2c_f32_bf16 v10, s45, v134
    v_dot2c_f32_bf16 v11, v134, v134
    v_dot2c_f32_bf16 v10, s45, v135
    v_dot2c_f32_bf16 v11, v135, v135
    s_waitcnt lgkmcnt(0)
    s_waitcnt vmcnt(10)
    s_barrier
    v_add_u32 v30, 98304, v4
    ds_read_b128 v[144:147], v30
    ds_read_b64_tr_b16 v[32:33], v1 offset:32768
    ds_read_b64_tr_b16 v[34:35], v1 offset:33280
    v_mfma_f32_32x32x16_bf16 v[64:79], v[36:39], v[136:139], v[64:79]
    v_mfma_f32_16x16x32_bf16 v[12:15], v[36:39], v[16:19], v[12:15]
    ds_read_b64_tr_b16 v[36:37], v1 offset:40960
    ds_read_b64_tr_b16 v[38:39], v1 offset:41472
    s_add_u32 m0, s30, 65536
    s_nop 0
    buffer_load_dwordx4 v9, s[52:55], s31 offen lds
    s_add_u32 m0, s30, 73728
    s_nop 0
    buffer_load_dwordx4 v9, s[56:59], s31 offen lds
    s_add_u32 s31, s31, s32
    s_cmp_eq_u32 s31, s23
    s_cselect_b32 s31, 0, s31
    v_mfma_f32_32x32x16_bf16 v[48:63], v[40:43], v[140:143], v[48:63]
    v_add_u32 v30, 98304, v5
    ds_read_b128 v[148:151], v30
    ds_read_b64_tr_b16 v[40:41], v2 offset:32768
    ds_read_b64_tr_b16 v[42:43], v2 offset:33280
    v_mfma_f32_32x32x16_bf16 v[64:79], v[44:47], v[140:143], v[64:79]
    ds_read_b64_tr_b16 v[44:45], v2 offset:40960
    ds_read_b64_tr_b16 v[46:47], v2 offset:41472
    s_add_u32 m0, s30, 81920
    s_add_u32 s33, s20, 0
    buffer_load_dwordx4 v8, s[48:51], s33 offen lds
    s_add_u32 m0, s30, 90112
    s_add_u32 s33, s20, 81920
    buffer_load_dwordx4 v8, s[48:51], s33 offen lds
    s_add_u32 s20, s20, 128
    s_cmp_eq_u32 s20, 1280
    s_cselect_b32 s20, 0, s20
    s_waitcnt lgkmcnt(9)
    s_waitcnt lgkmcnt(7)
    v_mfma_f32_32x32x16_bf16 v[48:63], v[32:35], v[144:147], v[48:63]
    v_mfma_f32_16x16x32_bf16 v[20:23], v[32:35], v[16:19], v[20:23]
    v_add_u32 v30, 98304, v6
    ds_read_b128 v[152:155], v30
    ds_read_b64_tr_b16 v[32:33], v3 offset:32768
    ds_read_b64_tr_b16 v[34:35], v3 offset:33280
    s_waitcnt lgkmcnt(8)
    v_mfma_f32_32x32x16_bf16 v[64:79], v[36:39], v[144:147], v[64:79]
    ds_read_b64_tr_b16 v[36:37], v3 offset:40960
    ds_read_b64_tr_b16 v[38:39], v3 offset:41472
    s_waitcnt lgkmcnt(9)
    s_waitcnt lgkmcnt(7)
    v_mfma_f32_32x32x16_bf16 v[48:63], v[40:43], v[148:151], v[48:63]
    v_add_u32 v30, 98304, v7
    ds_read_b128 v[156:159], v30
    ds_read_b64_tr_b16 v[40:41], v25 offset:32768
    ds_read_b64_tr_b16 v[42:43], v25 offset:33280
    s_waitcnt lgkmcnt(8)
    v_mfma_f32_32x32x16_bf16 v[64:79], v[44:47], v[148:151], v[64:79]
    ds_read_b64_tr_b16 v[44:45], v25 offset:40960
    ds_read_b64_tr_b16 v[46:47], v25 offset:41472
    s_waitcnt lgkmcnt(9)
    s_waitcnt lgkmcnt(7)
    v_mfma_f32_32x32x16_bf16 v[48:63], v[32:35], v[152:155], v[48:63]
    v_dot2c_f32_bf16 v10, s45, v144
    v_dot2c_f32_bf16 v11, v144, v144
    v_dot2c_f32_bf16 v10, s45, v145
    v_dot2c_f32_bf16 v11, v145, v145
    v_dot2c_f32_bf16 v10, s45, v146
    v_dot2c_f32_bf16 v11, v146, v146
    v_dot2c_f32_bf16 v10, s45, v147
    v_dot2c_f32_bf16 v11, v147, v147
    v_dot2c_f32_bf16 v10, s45, v148
    v_dot2c_f32_bf16 v11, v148, v148
    v_dot2c_f32_bf16 v10, s45, v149
    v_dot2c_f32_bf16 v11, v149, v149
    v_dot2c_f32_bf16 v10, s45, v150
    v_dot2c_f32_bf16 v11, v150, v150
    v_dot2c_f32_bf16 v10, s45, v151
    v_dot2c_f32_bf16 v11, v151, v151
    s_waitcnt lgkmcnt(0)
    s_waitcnt vmcnt(10)
    s_barrier
    v_add_u32 v30, 131072, v4
    ds_read_b128 v[160:163], v30
    v_add_u32 v1, 4294885376, v1
    ds_read_b64_tr_b16 v[32:33], v1 offset:0
    ds_read_b64_tr_b16 v[34:35], v1 offset:512
    v_mfma_f32_32x32x16_bf16 v[64:79], v[36:39], v[152:155], v[64:79]
    v_mfma_f32_16x16x32_bf16 v[12:15], v[36:39], v[16:19], v[12:15]
    ds_read_b64_tr_b16 v[36:37], v1 offset:8192
    ds_read_b64_tr_b16 v[38:39], v1 offset:8704
    s_add_u32 m0, s30, 98304
    s_nop 0
    buffer_load_dwordx4 v9, s[52:55], s31 offen lds
    s_add_u32 m0, s30, 106496
    s_nop 0
    buffer_load_dwordx4 v9, s[56:59], s31 offen lds
    s_add_u32 s31, s31, s32
    s_cmp_eq_u32 s31, s23
    s_cselect_b32 s31, 0, s31
    v_mfma_f32_32x32x16_bf16 v[48:63], v[40:43], v[156:159], v[48:63]
    v_add_u32 v30, 131072, v5
    ds_read_b128 v[164:167], v30
    v_add_u32 v2, 4294885376, v2
    ds_read_b64_tr_b16 v[40:41], v2 offset:0
    ds_read_b64_tr_b16 v[42:43], v2 offset:512
    v_mfma_f32_32x32x16_bf16 v[64:79], v[44:47], v[156:159], v[64:79]
    ds_read_b64_tr_b16 v[44:45], v2 offset:8192
    ds_read_b64_tr_b16 v[46:47], v2 offset:8704
    s_add_u32 m0, s30, 114688
    s_add_u32 s33, s20, 0
    buffer_load_dwordx4 v8, s[48:51], s33 offen lds
    s_add_u32 m0, s30, 122880
    s_add_u32 s33, s20, 81920
    buffer_load_dwordx4 v8, s[48:51], s33 offen lds
    s_add_u32 s20, s20, 128
    s_cmp_eq_u32 s20, 1280
    s_cselect_b32 s20, 0, s20
    s_waitcnt lgkmcnt(9)
    s_waitcnt lgkmcnt(7)
    v_mfma_f32_32x32x16_bf16 v[48:63], v[32:35], v[160:163], v[48:63]
    v_mfma_f32_16x16x32_bf16 v[20:23], v[32:35], v[16:19], v[20:23]
    v_add_u32 v30, 131072, v6
    ds_read_b128 v[168:171], v30
    v_add_u32 v3, 4294885376, v3
    ds_read_b64_tr_b16 v[32:33], v3 offset:0
    ds_read_b64_tr_b16 v[34:35], v3 offset:512
    s_waitcnt lgkmcnt(8)
    v_mfma_f32_32x32x16_bf16 v[64:79], v[36:39], v[160:163], v[64:79]
    ds_read_b64_tr_b16 v[36:37], v3 offset:8192
    ds_read_b64_tr_b16 v[38:39], v3 offset:8704
    s_waitcnt lgkmcnt(9)
    s_waitcnt lgkmcnt(7)
    v_mfma_f32_32x32x16_bf16 v[48:63], v[40:43], v[164:167], v[48:63]
    v_add_u32 v30, 131072, v7
    ds_read_b128 v[172:175], v30
    v_add_u32 v25, 4294885376, v25
    ds_read_b64_tr_b16 v[40:41], v25 offset:0
    ds_read_b64_tr_b16 v[42:43], v25 offset:512
    s_waitcnt lgkmcnt(8)
    v_mfma_f32_32x32x16_bf16 v[64:79], v[44:47], v[164:167], v[64:79]
    ds_read_b64_tr_b16 v[44:45], v25 offset:8192
    ds_read_b64_tr_b16 v[46:47], v25 offset:8704
    s_waitcnt lgkmcnt(9)
    s_waitcnt lgkmcnt(7)
    v_mfma_f32_32x32x16_bf16 v[48:63], v[32:35], v[168:171], v[48:63]
    v_dot2c_f32_bf16 v10, s45, v160
    v_dot2c_f32_bf16 v11, v160, v160
    v_dot2c_f32_bf16 v10, s45, v161
    v_dot2c_f32_bf16 v11, v161, v161
    v_dot2c_f32_bf16 v10, s45, v162
    v_dot2c_f32_bf16 v11, v162, v162
    v_dot2c_f32_bf16 v10, s45, v163
    v_dot2c_f32_bf16 v11, v163, v163
    v_dot2c_f32_bf16 v10, s45, v164
    v_dot2c_f32_bf16 v11, v164, v164
    v_dot2c_f32_bf16 v10, s45, v165
    v_dot2c_f32_bf16 v11, v165, v165
    v_dot2c_f32_bf16 v10, s45, v166
    v_dot2c_f32_bf16 v11, v166, v166
    v_dot2c_f32_bf16 v10, s45, v167
    v_dot2c_f32_bf16 v11, v167, v167
    s_waitcnt lgkmcnt(0)
    s_waitcnt vmcnt(10)
    s_barrier
    ds_read_b128 v[176:179], v4 offset:16384
    ds_read_b64_tr_b16 v[32:33], v1 offset:32768
    ds_read_b64_tr_b16 v[34:35], v1 offset:33280
    v_mfma_f32_32x32x16_bf16 v[64:79], v[36:39], v[168:171], v[64:79]
    v_mfma_f32_16x16x32_bf16 v[12:15], v[36:39], v[16:19], v[12:15]
    ds_read_b64_tr_b16 v[36:37], v1 offset:40960
    ds_read_b64_tr_b16 v[38:39], v1 offset:41472
    s_add_u32 m0, s30, 131072
    s_nop 0
    buffer_load_dwordx4 v9, s[52:55], s31 offen lds
    s_add_u32 m0, s30, 139264
    s_nop 0
    buffer_load_dwordx4 v9, s[56:59], s31 offen lds
    s_add_u32 s31, s31, s32
    s_cmp_eq_u32 s31, s23
    s_cselect_b32 s31, 0, s31
    v_mfma_f32_32x32x16_bf16 v[48:63], v[40:43], v[172:175], v[48:63]
    ds_read_b128 v[180:183], v5 offset:16384
    ds_read_b64_tr_b16 v[40:41], v2 offset:32768
    ds_read_b64_tr_b16 v[42:43], v2 offset:33280
    v_mfma_f32_32x32x16_bf16 v[64:79], v[44:47], v[172:175], v[64:79]
    ds_read_b64_tr_b16 v[44:45], v2 offset:40960
    ds_read_b64_tr_b16 v[46:47], v2 offset:41472
    s_add_u32 m0, s30, 0
    s_add_u32 s33, s20, 0
    buffer_load_dwordx4 v8, s[48:51], s33 offen lds
    s_add_u32 m0, s30, 8192
    s_add_u32 s33, s20, 81920
    buffer_load_dwordx4 v8, s[48:51], s33 offen lds
    s_add_u32 s20, s20, 128
    s_cmp_eq_u32 s20, 1280
    s_cselect_b32 s20, 0, s20
    s_waitcnt lgkmcnt(9)
    s_waitcnt lgkmcnt(7)
    v_mfma_f32_32x32x16_bf16 v[48:63], v[32:35], v[176:179], v[48:63]
    v_mfma_f32_16x16x32_bf16 v[20:23], v[32:35], v[16:19], v[20:23]
    ds_read_b128 v[184:187], v6 offset:16384
    ds_read_b64_tr_b16 v[32:33], v3 offset:32768
    ds_read_b64_tr_b16 v[34:35], v3 offset:33280
    s_waitcnt lgkmcnt(8)
    v_mfma_f32_32x32x16_bf16 v[64:79], v[36:39], v[176:179], v[64:79]
    ds_read_b64_tr_b16 v[36:37], v3 offset:40960
    ds_read_b64_tr_b16 v[38:39], v3 offset:41472
    s_waitcnt lgkmcnt(9)
    s_waitcnt lgkmcnt(7)
    v_mfma_f32_32x32x16_bf16 v[48:63], v[40:43], v[180:183], v[48:63]
    ds_read_b128 v[188:191], v7 offset:16384
    ds_read_b64_tr_b16 v[40:41], v25 offset:32768
    ds_read_b64_tr_b16 v[42:43], v25 offset:33280
    s_waitcnt lgkmcnt(8)
    v_mfma_f32_32x32x16_bf16 v[64:79], v[44:47], v[180:183], v[64:79]
    ds_read_b64_tr_b16 v[44:45], v25 offset:40960
    ds_read_b64_tr_b16 v[46:47], v25 offset:41472
    s_waitcnt lgkmcnt(9)
    s_waitcnt lgkmcnt(7)
    v_mfma_f32_32x32x16_bf16 v[48:63], v[32:35], v[184:187], v[48:63]
    v_dot2c_f32_bf16 v10, s45, v176
    v_dot2c_f32_bf16 v11, v176, v176
    v_dot2c_f32_bf16 v10, s45, v177
    v_dot2c_f32_bf16 v11, v177, v177
    v_dot2c_f32_bf16 v10, s45, v178
    v_dot2c_f32_bf16 v11, v178, v178
    v_dot2c_f32_bf16 v10, s45, v179
    v_dot2c_f32_bf16 v11, v179, v179
    v_dot2c_f32_bf16 v10, s45, v180
    v_dot2c_f32_bf16 v11, v180, v180
    v_dot2c_f32_bf16 v10, s45, v181
    v_dot2c_f32_bf16 v11, v181, v181
    v_dot2c_f32_bf16 v10, s45, v182
    v_dot2c_f32_bf16 v11, v182, v182
    v_dot2c_f32_bf16 v10, s45, v183
    v_dot2c_f32_bf16 v11, v183, v183
    s_waitcnt lgkmcnt(0)
    s_waitcnt vmcnt(10)
    s_barrier
    ds_read_b128 v[192:195], v4 offset:49152
    v_add_u32 v1, 65536, v1
    ds_read_b64_tr_b16 v[32:33], v1 offset:0
    ds_read_b64_tr_b16 v[34:35], v1 offset:512
    v_mfma_f32_32x32x16_bf16 v[64:79], v[36:39], v[184:187], v[64:79]
    v_mfma_f32_16x16x32_bf16 v[12:15], v[36:39], v[16:19], v[12:15]
    ds_read_b64_tr_b16 v[36:37], v1 offset:8192
    ds_read_b64_tr_b16 v[38:39], v1 offset:8704
    s_add_u32 m0, s30, 16384
    s_nop 0
    buffer_load_dwordx4 v9, s[52:55], s31 offen lds
    s_add_u32 m0, s30, 24576
    s_nop 0
    buffer_load_dwordx4 v9, s[56:59], s31 offen lds
    s_add_u32 s31, s31, s32
    s_cmp_eq_u32 s31, s23
    s_cselect_b32 s31, 0, s31
    v_lshrrev_b32 v8, 3, v0
    s_lshl_b32 s33, s24, 3
    v_add_u32 v8, s33, v8
    v_bfe_u32 v30, v8, 1, 1
    v_lshlrev_b32 v30, 2, v30
    v_and_b32 v9, 7, v0
    v_xor_b32 v30, v30, v9
    v_lshlrev_b32 v30, 4, v30
    v_mul_u32_u24 v9, 3072, v8
    v_mul_u32_u24 v8, 3840, v8
    v_add_u32 v9, v9, v30
    v_add_u32 v8, v8, v30
    v_mfma_f32_32x32x16_bf16 v[48:63], v[40:43], v[188:191], v[48:63]
    ds_read_b128 v[196:199], v5 offset:49152
    v_add_u32 v2, 65536, v2
    ds_read_b64_tr_b16 v[40:41], v2 offset:0
    ds_read_b64_tr_b16 v[42:43], v2 offset:512
    v_mfma_f32_32x32x16_bf16 v[64:79], v[44:47], v[188:191], v[64:79]
    ds_read_b64_tr_b16 v[44:45], v2 offset:8192
    ds_read_b64_tr_b16 v[46:47], v2 offset:8704
    s_add_u32 m0, s30, 32768
    s_nop 0
    buffer_load_dwordx4 v8, s[60:63], s21 offen lds
    s_add_u32 s21, s21, 245760
    s_cmp_eq_u32 s21, 2457600
    s_cselect_b32 s21, 0, s21
    s_add_u32 m0, s30, 40960
    s_nop 0
    buffer_load_dwordx4 v8, s[60:63], s21 offen lds
    s_add_u32 s21, s21, 245760
    s_cmp_eq_u32 s21, 2457600
    s_cselect_b32 s21, 0, s21
    s_waitcnt lgkmcnt(9)
    s_waitcnt lgkmcnt(7)
    v_mfma_f32_32x32x16_bf16 v[48:63], v[32:35], v[192:195], v[48:63]
    v_mfma_f32_16x16x32_bf16 v[20:23], v[32:35], v[16:19], v[20:23]
    ds_read_b128 v[200:203], v6 offset:49152
    v_add_u32 v3, 65536, v3
    ds_read_b64_tr_b16 v[32:33], v3 offset:0
    ds_read_b64_tr_b16 v[34:35], v3 offset:512
    s_waitcnt lgkmcnt(8)
    v_mfma_f32_32x32x16_bf16 v[64:79], v[36:39], v[192:195], v[64:79]
    ds_read_b64_tr_b16 v[36:37], v3 offset:8192
    ds_read_b64_tr_b16 v[38:39], v3 offset:8704
    s_waitcnt lgkmcnt(9)
    s_waitcnt lgkmcnt(7)
    v_mfma_f32_32x32x16_bf16 v[48:63], v[40:43], v[196:199], v[48:63]
    ds_read_b128 v[204:207], v7 offset:49152
    v_add_u32 v25, 65536, v25
    ds_read_b64_tr_b16 v[40:41], v25 offset:0
    ds_read_b64_tr_b16 v[42:43], v25 offset:512
    s_waitcnt lgkmcnt(8)
    v_mfma_f32_32x32x16_bf16 v[64:79], v[44:47], v[196:199], v[64:79]
    ds_read_b64_tr_b16 v[44:45], v25 offset:8192
    ds_read_b64_tr_b16 v[46:47], v25 offset:8704
    s_waitcnt lgkmcnt(9)
    s_waitcnt lgkmcnt(7)
    v_mfma_f32_32x32x16_bf16 v[48:63], v[32:35], v[200:203], v[48:63]
    v_dot2c_f32_bf16 v10, s45, v192
    v_dot2c_f32_bf16 v11, v192, v192
    v_dot2c_f32_bf16 v10, s45, v193
    v_dot2c_f32_bf16 v11, v193, v193
    v_dot2c_f32_bf16 v10, s45, v194
    v_dot2c_f32_bf16 v11, v194, v194
    v_dot2c_f32_bf16 v10, s45, v195
    v_dot2c_f32_bf16 v11, v195, v195
    v_dot2c_f32_bf16 v10, s45, v196
    v_dot2c_f32_bf16 v11, v196, v196
    v_dot2c_f32_bf16 v10, s45, v197
    v_dot2c_f32_bf16 v11, v197, v197
    v_dot2c_f32_bf16 v10, s45, v198
    v_dot2c_f32_bf16 v11, v198, v198
    v_dot2c_f32_bf16 v10, s45, v199
    v_dot2c_f32_bf16 v11, v199, v199
    s_waitcnt lgkmcnt(0)
    s_waitcnt vmcnt(10)
    s_barrier
    v_add_u32 v30, 81920, v4
    ds_read_b128 v[208:211], v30
    ds_read_b64_tr_b16 v[32:33], v1 offset:32768
    ds_read_b64_tr_b16 v[34:35], v1 offset:33280
    v_mfma_f32_32x32x16_bf16 v[64:79], v[36:39], v[200:203], v[64:79]
    v_mfma_f32_16x16x32_bf16 v[12:15], v[36:39], v[16:19], v[12:15]
    ds_read_b64_tr_b16 v[36:37], v1 offset:40960
    ds_read_b64_tr_b16 v[38:39], v1 offset:41472
    s_add_u32 m0, s30, 49152
    s_nop 0
    buffer_load_dwordx4 v8, s[60:63], s21 offen lds
    s_add_u32 s21, s21, 245760
    s_cmp_eq_u32 s21, 2457600
    s_cselect_b32 s21, 0, s21
    s_add_u32 m0, s30, 57344
    s_nop 0
    buffer_load_dwordx4 v8, s[60:63], s21 offen lds
    s_add_u32 s21, s21, 245760
    s_cmp_eq_u32 s21, 2457600
    s_cselect_b32 s21, 0, s21
    v_mfma_f32_32x32x16_bf16 v[48:63], v[40:43], v[204:207], v[48:63]
    v_add_u32 v30, 81920, v5
    ds_read_b128 v[212:215], v30
    ds_read_b64_tr_b16 v[40:41], v2 offset:32768
    ds_read_b64_tr_b16 v[42:43], v2 offset:33280
    v_mfma_f32_32x32x16_bf16 v[64:79], v[44:47], v[204:207], v[64:79]
    ds_read_b64_tr_b16 v[44:45], v2 offset:40960
    ds_read_b64_tr_b16 v[46:47], v2 offset:41472
    s_add_u32 m0, s30, 65536
    s_nop 0
    buffer_load_dwordx4 v8, s[60:63], s21 offen lds
    s_add_u32 s21, s21, 245760
    s_cmp_eq_u32 s21, 2457600
    s_cselect_b32 s21, 0, s21
    s_add_u32 m0, s30, 73728
    s_nop 0
    buffer_load_dwordx4 v8, s[60:63], s21 offen lds
    s_add_u32 s21, s21, 245760
    s_cmp_eq_u32 s21, 2457600
    s_cselect_b32 s21, 0, s21
    s_waitcnt lgkmcnt(9)
    s_waitcnt lgkmcnt(7)
    v_mfma_f32_32x32x16_bf16 v[48:63], v[32:35], v[208:211], v[48:63]
    v_mfma_f32_16x16x32_bf16 v[20:23], v[32:35], v[16:19], v[20:23]
    v_add_u32 v30, 81920, v6
    ds_read_b128 v[216:219], v30
    ds_read_b64_tr_b16 v[32:33], v3 offset:32768
    ds_read_b64_tr_b16 v[34:35], v3 offset:33280
    s_waitcnt lgkmcnt(8)
    v_mfma_f32_32x32x16_bf16 v[64:79], v[36:39], v[208:211], v[64:79]
    ds_read_b64_tr_b16 v[36:37], v3 offset:40960
    ds_read_b64_tr_b16 v[38:39], v3 offset:41472
    s_waitcnt lgkmcnt(9)
    s_waitcnt lgkmcnt(7)
    v_mfma_f32_32x32x16_bf16 v[48:63], v[40:43], v[212:215], v[48:63]
    v_add_u32 v30, 81920, v7
    ds_read_b128 v[220:223], v30
    ds_read_b64_tr_b16 v[40:41], v25 offset:32768
    ds_read_b64_tr_b16 v[42:43], v25 offset:33280
    s_waitcnt lgkmcnt(8)
    v_mfma_f32_32x32x16_bf16 v[64:79], v[44:47], v[212:215], v[64:79]
    ds_read_b64_tr_b16 v[44:45], v25 offset:40960
    ds_read_b64_tr_b16 v[46:47], v25 offset:41472
    s_waitcnt lgkmcnt(9)
    s_waitcnt lgkmcnt(7)
    v_mfma_f32_32x32x16_bf16 v[48:63], v[32:35], v[216:219], v[48:63]
    v_dot2c_f32_bf16 v10, s45, v208
    v_dot2c_f32_bf16 v11, v208, v208
    v_dot2c_f32_bf16 v10, s45, v209
    v_dot2c_f32_bf16 v11, v209, v209
    v_dot2c_f32_bf16 v10, s45, v210
    v_dot2c_f32_bf16 v11, v210, v210
    v_dot2c_f32_bf16 v10, s45, v211
    v_dot2c_f32_bf16 v11, v211, v211
    v_dot2c_f32_bf16 v10, s45, v212
    v_dot2c_f32_bf16 v11, v212, v212
    v_dot2c_f32_bf16 v10, s45, v213
    v_dot2c_f32_bf16 v11, v213, v213
    v_dot2c_f32_bf16 v10, s45, v214
    v_dot2c_f32_bf16 v11, v214, v214
    v_dot2c_f32_bf16 v10, s45, v215
    v_dot2c_f32_bf16 v11, v215, v215
    s_waitcnt lgkmcnt(0)
    s_waitcnt vmcnt(10)
    s_barrier
    v_add_u32 v30, 114688, v4
    ds_read_b128 v[224:227], v30
    v_add_u32 v1, 65536, v1
    ds_read_b64_tr_b16 v[32:33], v1 offset:0
    ds_read_b64_tr_b16 v[34:35], v1 offset:512
    v_mfma_f32_32x32x16_bf16 v[64:79], v[36:39], v[216:219], v[64:79]
    v_mfma_f32_16x16x32_bf16 v[12:15], v[36:39], v[16:19], v[12:15]
    ds_read_b64_tr_b16 v[36:37], v1 offset:8192
    ds_read_b64_tr_b16 v[38:39], v1 offset:8704
    s_add_u32 m0, s30, 81920
    s_nop 0
    buffer_load_dwordx4 v8, s[60:63], s21 offen lds
    s_add_u32 s21, s21, 245760
    s_cmp_eq_u32 s21, 2457600
    s_cselect_b32 s21, 0, s21
    s_add_u32 m0, s30, 90112
    s_nop 0
    buffer_load_dwordx4 v8, s[60:63], s21 offen lds
    s_add_u32 s21, s21, 245760
    s_cmp_eq_u32 s21, 2457600
    s_cselect_b32 s21, 0, s21
    v_mfma_f32_32x32x16_bf16 v[48:63], v[40:43], v[220:223], v[48:63]
    v_add_u32 v30, 114688, v5
    ds_read_b128 v[228:231], v30
    v_add_u32 v2, 65536, v2
    ds_read_b64_tr_b16 v[40:41], v2 offset:0
    ds_read_b64_tr_b16 v[42:43], v2 offset:512
    v_mfma_f32_32x32x16_bf16 v[64:79], v[44:47], v[220:223], v[64:79]
    ds_read_b64_tr_b16 v[44:45], v2 offset:8192
    ds_read_b64_tr_b16 v[46:47], v2 offset:8704
    s_add_u32 m0, s30, 98304
    s_nop 0
    buffer_load_dwordx4 v8, s[60:63], s21 offen lds
    s_add_u32 s21, s21, 245760
    s_cmp_eq_u32 s21, 2457600
    s_cselect_b32 s21, 0, s21
    s_add_u32 m0, s30, 106496
    s_nop 0
    buffer_load_dwordx4 v8, s[60:63], s21 offen lds
    s_add_u32 s21, s21, 245760
    s_cmp_eq_u32 s21, 2457600
    s_cselect_b32 s21, 0, s21
    s_waitcnt lgkmcnt(9)
    s_waitcnt lgkmcnt(7)
    v_mfma_f32_32x32x16_bf16 v[48:63], v[32:35], v[224:227], v[48:63]
    v_mfma_f32_16x16x32_bf16 v[20:23], v[32:35], v[16:19], v[20:23]
    v_add_u32 v30, 114688, v6
    ds_read_b128 v[232:235], v30
    v_add_u32 v3, 65536, v3
    ds_read_b64_tr_b16 v[32:33], v3 offset:0
    ds_read_b64_tr_b16 v[34:35], v3 offset:512
    s_waitcnt lgkmcnt(8)
    v_mfma_f32_32x32x16_bf16 v[64:79], v[36:39], v[224:227], v[64:79]
    ds_read_b64_tr_b16 v[36:37], v3 offset:8192
    ds_read_b64_tr_b16 v[38:39], v3 offset:8704
    s_waitcnt lgkmcnt(9)
    s_waitcnt lgkmcnt(7)
    v_mfma_f32_32x32x16_bf16 v[48:63], v[40:43], v[228:231], v[48:63]
    v_add_u32 v30, 114688, v7
    ds_read_b128 v[236:239], v30
    v_add_u32 v25, 65536, v25
    ds_read_b64_tr_b16 v[40:41], v25 offset:0
    ds_read_b64_tr_b16 v[42:43], v25 offset:512
    s_waitcnt lgkmcnt(8)
    v_mfma_f32_32x32x16_bf16 v[64:79], v[44:47], v[228:231], v[64:79]
    ds_read_b64_tr_b16 v[44:45], v25 offset:8192
    ds_read_b64_tr_b16 v[46:47], v25 offset:8704
    s_waitcnt lgkmcnt(9)
    s_waitcnt lgkmcnt(7)
    v_mfma_f32_32x32x16_bf16 v[48:63], v[32:35], v[232:235], v[48:63]
    v_dot2c_f32_bf16 v10, s45, v224
    v_dot2c_f32_bf16 v11, v224, v224
    v_dot2c_f32_bf16 v10, s45, v225
    v_dot2c_f32_bf16 v11, v225, v225
    v_dot2c_f32_bf16 v10, s45, v226
    v_dot2c_f32_bf16 v11, v226, v226
    v_dot2c_f32_bf16 v10, s45, v227
    v_dot2c_f32_bf16 v11, v227, v227
    v_dot2c_f32_bf16 v10, s45, v228
    v_dot2c_f32_bf16 v11, v228, v228
    v_dot2c_f32_bf16 v10, s45, v229
    v_dot2c_f32_bf16 v11, v229, v229
    v_dot2c_f32_bf16 v10, s45, v230
    v_dot2c_f32_bf16 v11, v230, v230
    v_dot2c_f32_bf16 v10, s45, v231
    v_dot2c_f32_bf16 v11, v231, v231
    s_waitcnt lgkmcnt(0)
    s_waitcnt vmcnt(10)
    s_barrier
    ds_read_b128 v[240:243], v4 offset:0
    v_add_u32 v1, 4294852608, v1
    ds_read_b64_tr_b16 v[32:33], v1 offset:0
    ds_read_b64_tr_b16 v[34:35], v1 offset:512
    v_mfma_f32_32x32x16_bf16 v[64:79], v[36:39], v[232:235], v[64:79]
    v_mfma_f32_16x16x32_bf16 v[12:15], v[36:39], v[16:19], v[12:15]
    ds_read_b64_tr_b16 v[36:37], v1 offset:8192
    ds_read_b64_tr_b16 v[38:39], v1 offset:8704
    s_add_u32 m0, s30, 114688
    s_nop 0
    buffer_load_dwordx4 v9, s[64:67], s22 offen lds
    s_add_u32 m0, s30, 122880
    s_nop 0
    buffer_load_dwordx4 v9, s[68:71], s22 offen lds
    s_add_u32 s22, s22, 196608
    s_cmp_eq_u32 s22, 1966080
    s_cselect_b32 s22, 0, s22
    v_mfma_f32_32x32x16_bf16 v[48:63], v[40:43], v[236:239], v[48:63]
    ds_read_b128 v[244:247], v5 offset:0
    v_add_u32 v2, 4294852608, v2
    ds_read_b64_tr_b16 v[40:41], v2 offset:0
    ds_read_b64_tr_b16 v[42:43], v2 offset:512
    v_mfma_f32_32x32x16_bf16 v[64:79], v[44:47], v[236:239], v[64:79]
    ds_read_b64_tr_b16 v[44:45], v2 offset:8192
    ds_read_b64_tr_b16 v[46:47], v2 offset:8704
    s_add_u32 m0, s30, 131072
    s_nop 0
    buffer_load_dwordx4 v9, s[64:67], s22 offen lds
    s_add_u32 m0, s30, 139264
    s_nop 0
    buffer_load_dwordx4 v9, s[68:71], s22 offen lds
    s_add_u32 s22, s22, 196608
    s_cmp_eq_u32 s22, 1966080
    s_cselect_b32 s22, 0, s22
    s_waitcnt lgkmcnt(9)
    s_waitcnt lgkmcnt(7)
    v_mfma_f32_32x32x16_bf16 v[48:63], v[32:35], v[240:243], v[48:63]
    v_mfma_f32_16x16x32_bf16 v[20:23], v[32:35], v[16:19], v[20:23]
    ds_read_b128 v[248:251], v6 offset:0
    v_add_u32 v3, 4294852608, v3
    ds_read_b64_tr_b16 v[32:33], v3 offset:0
    ds_read_b64_tr_b16 v[34:35], v3 offset:512
    s_waitcnt lgkmcnt(8)
    v_mfma_f32_32x32x16_bf16 v[64:79], v[36:39], v[240:243], v[64:79]
    ds_read_b64_tr_b16 v[36:37], v3 offset:8192
    ds_read_b64_tr_b16 v[38:39], v3 offset:8704
    s_waitcnt lgkmcnt(9)
    s_waitcnt lgkmcnt(7)
    v_mfma_f32_32x32x16_bf16 v[48:63], v[40:43], v[244:247], v[48:63]
    ds_read_b128 v[252:255], v7 offset:0
    v_add_u32 v25, 4294852608, v25
    ds_read_b64_tr_b16 v[40:41], v25 offset:0
    ds_read_b64_tr_b16 v[42:43], v25 offset:512
    s_waitcnt lgkmcnt(8)
    v_mfma_f32_32x32x16_bf16 v[64:79], v[44:47], v[244:247], v[64:79]
    ds_read_b64_tr_b16 v[44:45], v25 offset:8192
    ds_read_b64_tr_b16 v[46:47], v25 offset:8704
    s_waitcnt lgkmcnt(9)
    s_waitcnt lgkmcnt(7)
    v_mfma_f32_32x32x16_bf16 v[48:63], v[32:35], v[248:251], v[48:63]
    v_dot2c_f32_bf16 v10, s45, v240
    v_dot2c_f32_bf16 v11, v240, v240
    v_dot2c_f32_bf16 v10, s45, v241
    v_dot2c_f32_bf16 v11, v241, v241
    v_dot2c_f32_bf16 v10, s45, v242
    v_dot2c_f32_bf16 v11, v242, v242
    v_dot2c_f32_bf16 v10, s45, v243
    v_dot2c_f32_bf16 v11, v243, v243
    v_dot2c_f32_bf16 v10, s45, v244
    v_dot2c_f32_bf16 v11, v244, v244
    v_dot2c_f32_bf16 v10, s45, v245
    v_dot2c_f32_bf16 v11, v245, v245
    v_dot2c_f32_bf16 v10, s45, v246
    v_dot2c_f32_bf16 v11, v246, v246
    v_dot2c_f32_bf16 v10, s45, v247
    v_dot2c_f32_bf16 v11, v247, v247
    s_waitcnt lgkmcnt(0)
    s_waitcnt vmcnt(12)
    s_barrier
    ds_read_b64_tr_b16 v[32:33], v1 offset:16384
    ds_read_b64_tr_b16 v[34:35], v1 offset:16896
    v_mfma_f32_32x32x16_bf16 v[64:79], v[36:39], v[248:251], v[64:79]
    v_mfma_f32_16x16x32_bf16 v[12:15], v[36:39], v[16:19], v[12:15]
    ds_read_b64_tr_b16 v[36:37], v2 offset:16384
    ds_read_b64_tr_b16 v[38:39], v2 offset:16896
    s_add_u32 m0, s30, 0
    s_nop 0
    buffer_load_dwordx4 v9, s[64:67], s22 offen lds
    s_add_u32 m0, s30, 8192
    s_nop 0
    buffer_load_dwordx4 v9, s[68:71], s22 offen lds
    s_add_u32 s22, s22, 196608
    s_cmp_eq_u32 s22, 1966080
    s_cselect_b32 s22, 0, s22
    v_mfma_f32_32x32x16_bf16 v[48:63], v[40:43], v[252:255], v[48:63]
    ds_read_b64_tr_b16 v[40:41], v3 offset:16384
    ds_read_b64_tr_b16 v[42:43], v3 offset:16896
    v_mfma_f32_32x32x16_bf16 v[64:79], v[44:47], v[252:255], v[64:79]
    ds_read_b64_tr_b16 v[44:45], v25 offset:16384
    ds_read_b64_tr_b16 v[46:47], v25 offset:16896
    s_add_u32 m0, s30, 16384
    s_nop 0
    buffer_load_dwordx4 v9, s[64:67], s22 offen lds
    s_add_u32 m0, s30, 24576
    s_nop 0
    buffer_load_dwordx4 v9, s[68:71], s22 offen lds
    s_add_u32 s22, s22, 196608
    s_cmp_eq_u32 s22, 1966080
    s_cselect_b32 s22, 0, s22
    v_and_b32 v30, 0x31, v0
    v_mul_u32_u24 v30, 0x104, v30
    v_and_b32 v30, 0x1c0, v30
    v_add_u32 v30, s3, v30
    s_nop 4
    ds_write_b32 v30, v20 offset:0
    ds_write_b32 v30, v21 offset:16
    ds_write_b32 v30, v22 offset:32
    ds_write_b32 v30, v23 offset:48
    ds_write_b32 v30, v12 offset:2048
    ds_write_b32 v30, v13 offset:2064
    ds_write_b32 v30, v14 offset:2080
    ds_write_b32 v30, v15 offset:2096
    v_lshl_add_u32 v30, v0, 3, s10
    v_add_u32 v30, s11, v30
    ds_write_b64 v30, v[10:11]
    s_cmp_eq_u32 s29, 1
    s_cbranch_scc1 K1Y_1
    s_waitcnt lgkmcnt(15)
    v_mfma_f32_32x32x16_bf16 v[80:95], v[32:35], v[96:99], 0
    v_mfma_f32_16x16x32_bf16 v[20:23], v[32:35], v[16:19], 0
    ds_read_b64_tr_b16 v[32:33], v1 offset:24576
    ds_read_b64_tr_b16 v[34:35], v1 offset:25088
    s_waitcnt lgkmcnt(15)
    v_mfma_f32_32x32x16_bf16 v[80:95], v[36:39], v[100:103], v[80:95]
    ds_read_b64_tr_b16 v[36:37], v2 offset:24576
    ds_read_b64_tr_b16 v[38:39], v2 offset:25088
    s_waitcnt lgkmcnt(15)
    v_mfma_f32_32x32x16_bf16 v[80:95], v[40:43], v[104:107], v[80:95]
    ds_read_b64_tr_b16 v[40:41], v3 offset:24576
    ds_read_b64_tr_b16 v[42:43], v3 offset:25088
    s_waitcnt lgkmcnt(15)
    v_mfma_f32_32x32x16_bf16 v[80:95], v[44:47], v[108:111], v[80:95]
    ds_read_b64_tr_b16 v[44:45], v25 offset:24576
    ds_read_b64_tr_b16 v[46:47], v25 offset:25088
    s_waitcnt lgkmcnt(6)
    v_mfma_f32_32x32x16_bf16 v[80:95], v[32:35], v[112:115], v[80:95]
    v_mfma_f32_16x16x32_bf16 v[20:23], v[32:35], v[16:19], v[20:23]
    s_waitcnt lgkmcnt(0)
    s_waitcnt vmcnt(14)
    s_barrier
    ds_read_b64_tr_b16 v[32:33], v1 offset:32768
    ds_read_b64_tr_b16 v[34:35], v1 offset:33280
    v_mfma_f32_32x32x16_bf16 v[80:95], v[36:39], v[116:119], v[80:95]
    ds_read_b64_tr_b16 v[36:37], v2 offset:32768
    ds_read_b64_tr_b16 v[38:39], v2 offset:33280
    s_add_u32 m0, s30, 32768
    s_nop 0
    buffer_load_dwordx4 v9, s[64:67], s22 offen lds
    s_add_u32 m0, s30, 40960
    s_nop 0
    buffer_load_dwordx4 v9, s[68:71], s22 offen lds
    s_add_u32 s22, s22, 196608
    s_cmp_eq_u32 s22, 1966080
    s_cselect_b32 s22, 0, s22
    v_lshl_add_u32 v30, v0, 3, s10
    v_add_u32 v30, s11, v30
    v_xor_b32 v30, 512, v30
    ds_read_b64 v[4:5], v30
    v_mfma_f32_32x32x16_bf16 v[80:95], v[40:43], v[120:123], v[80:95]
    ds_read_b64_tr_b16 v[40:41], v3 offset:32768
    ds_read_b64_tr_b16 v[42:43], v3 offset:33280
    s_waitcnt lgkmcnt(2)
    v_mfma_f32_32x32x16_bf16 v[80:95], v[44:47], v[124:127], v[80:95]
    ds_read_b64_tr_b16 v[44:45], v25 offset:32768
    ds_read_b64_tr_b16 v[46:47], v25 offset:33280
    v_add_f32 v14, v10, v4
    v_add_f32 v15, v11, v5
    v_mov_b32 v4, v14
    v_mov_b32 v5, v15
    v_mfma_f32_32x32x16_bf16 v[80:95], v[32:35], v[128:131], v[80:95]
    v_mfma_f32_16x16x32_bf16 v[20:23], v[32:35], v[16:19], v[20:23]
    ds_read_b64_tr_b16 v[32:33], v1 offset:40960
    ds_read_b64_tr_b16 v[34:35], v1 offset:41472
    s_nop 1
    v_permlane32_swap_b32 v14, v4
    v_permlane32_swap_b32 v15, v5
    v_add_f32 v14, v14, v4
    v_add_f32 v15, v15, v5
    v_mul_f32 v14, 0xbacccccd, v14
    v_mfma_f32_32x32x16_bf16 v[80:95], v[36:39], v[132:135], v[80:95]
    ds_read_b64_tr_b16 v[36:37], v2 offset:40960
    ds_read_b64_tr_b16 v[38:39], v2 offset:41472
    v_mul_f32 v15, 0x3acccccd, v15
    v_fma_f32 v15, -v14, v14, v15
    v_max_f32 v15, 0, v15
    v_mul_f32 v14, 0.5, v14
    s_waitcnt lgkmcnt(6)
    v_mfma_f32_32x32x16_bf16 v[80:95], v[40:43], v[136:139], v[80:95]
    ds_read_b64_tr_b16 v[40:41], v3 offset:40960
    ds_read_b64_tr_b16 v[42:43], v3 offset:41472
    v_add_f32 v15, 0x3727c5ac, v15
    v_rsq_f32 v24, v15
    v_cvt_pk_bf16_f32 v10, v14, v14
    v_and_b32 v4, s93, v10
    s_waitcnt lgkmcnt(6)
    v_mfma_f32_32x32x16_bf16 v[80:95], v[44:47], v[140:143], v[80:95]
    ds_read_b64_tr_b16 v[44:45], v25 offset:40960
    ds_read_b64_tr_b16 v[46:47], v25 offset:41472
    v_sub_f32 v4, v14, v4
    v_cvt_pk_bf16_f32 v11, v4, v4
    v_mul_f32 v28, v24, v24
    ds_read_b128 v[4:7], v31 offset:0
    s_waitcnt lgkmcnt(7)
    v_mfma_f32_32x32x16_bf16 v[80:95], v[32:35], v[144:147], v[80:95]
    v_mfma_f32_16x16x32_bf16 v[20:23], v[32:35], v[16:19], v[20:23]
    s_waitcnt lgkmcnt(0)
    s_waitcnt vmcnt(14)
    s_barrier
    ds_read_b64_tr_b16 v[32:33], v1 offset:49152
    ds_read_b64_tr_b16 v[34:35], v1 offset:49664
    v_mfma_f32_32x32x16_bf16 v[80:95], v[36:39], v[148:151], v[80:95]
    ds_read_b64_tr_b16 v[36:37], v2 offset:49152
    ds_read_b64_tr_b16 v[38:39], v2 offset:49664
    s_add_u32 m0, s30, 49152
    s_nop 0
    buffer_load_dwordx4 v9, s[64:67], s22 offen lds
    s_add_u32 m0, s30, 57344
    s_nop 0
    buffer_load_dwordx4 v9, s[68:71], s22 offen lds
    s_add_u32 s22, s22, 196608
    s_cmp_eq_u32 s22, 1966080
    s_cselect_b32 s22, 0, s22
    v_add_f32 v4, v4, v5
    v_mfma_f32_32x32x16_bf16 v[80:95], v[40:43], v[152:155], v[80:95]
    ds_read_b64_tr_b16 v[40:41], v3 offset:49152
    ds_read_b64_tr_b16 v[42:43], v3 offset:49664
    v_add_f32 v6, v6, v7
    v_add_f32 v4, v4, v6
    v_cvt_pk_bf16_f32 v6, v4, v4
    v_and_b32 v6, s93, v6
    v_mfma_f32_32x32x16_bf16 v[80:95], v[44:47], v[156:159], v[80:95]
    ds_read_b64_tr_b16 v[44:45], v25 offset:49152
    ds_read_b64_tr_b16 v[46:47], v25 offset:49664
    v_sub_f32 v7, v4, v6
    v_cvt_pk_bf16_f32 v6, v4, v7
    v_cvt_pk_bf16_f32 v7, v4, v7
    s_nop 1
    v_mfma_f32_32x32x8bf16_1k v[48:63], v[6:7], v[10:11], v[48:63]
    ds_read_b128 v[4:7], v31 offset:2048
    s_waitcnt lgkmcnt(7)
    v_mfma_f32_32x32x16_bf16 v[80:95], v[32:35], v[160:163], v[80:95]
    v_mfma_f32_16x16x32_bf16 v[20:23], v[32:35], v[16:19], v[20:23]
    ds_read_b64_tr_b16 v[32:33], v1 offset:57344
    ds_read_b64_tr_b16 v[34:35], v1 offset:57856
    s_waitcnt lgkmcnt(7)
    v_mfma_f32_32x32x16_bf16 v[80:95], v[36:39], v[164:167], v[80:95]
    ds_read_b64_tr_b16 v[36:37], v2 offset:57344
    ds_read_b64_tr_b16 v[38:39], v2 offset:57856
    s_waitcnt lgkmcnt(4)
    v_add_f32 v4, v4, v5
    v_add_f32 v6, v6, v7
    v_mfma_f32_32x32x16_bf16 v[80:95], v[40:43], v[168:171], v[80:95]
    ds_read_b64_tr_b16 v[40:41], v3 offset:57344
    ds_read_b64_tr_b16 v[42:43], v3 offset:57856
    v_add_f32 v4, v4, v6
    v_cvt_pk_bf16_f32 v6, v4, v4
    v_and_b32 v6, s93, v6
    v_sub_f32 v7, v4, v6
    v_mfma_f32_32x32x16_bf16 v[80:95], v[44:47], v[172:175], v[80:95]
    ds_read_b64_tr_b16 v[44:45], v25 offset:57344
    ds_read_b64_tr_b16 v[46:47], v25 offset:57856
    v_cvt_pk_bf16_f32 v6, v4, v7
    v_cvt_pk_bf16_f32 v7, v4, v7
    s_nop 1
    v_mfma_f32_32x32x8bf16_1k v[64:79], v[6:7], v[10:11], v[64:79]
    s_waitcnt lgkmcnt(6)
    v_mfma_f32_32x32x16_bf16 v[80:95], v[32:35], v[176:179], v[80:95]
    v_mfma_f32_16x16x32_bf16 v[20:23], v[32:35], v[16:19], v[20:23]
    s_waitcnt lgkmcnt(0)
    s_waitcnt vmcnt(14)
    s_barrier
    v_add_u32 v1, 65536, v1
    ds_read_b64_tr_b16 v[32:33], v1 offset:0
    ds_read_b64_tr_b16 v[34:35], v1 offset:512
    v_mfma_f32_32x32x16_bf16 v[80:95], v[36:39], v[180:183], v[80:95]
    v_add_u32 v2, 65536, v2
    ds_read_b64_tr_b16 v[36:37], v2 offset:0
    ds_read_b64_tr_b16 v[38:39], v2 offset:512
    s_add_u32 m0, s30, 65536
    s_nop 0
    buffer_load_dwordx4 v9, s[64:67], s22 offen lds
    s_add_u32 m0, s30, 73728
    s_nop 0
    buffer_load_dwordx4 v9, s[68:71], s22 offen lds
    s_add_u32 s22, s22, 196608
    s_cmp_eq_u32 s22, 1966080
    s_cselect_b32 s22, 0, s22
    v_mul_f32 v48, v48, v64
    v_mul_f32 v49, v49, v65
    v_mul_f32 v50, v50, v66
    v_mfma_f32_32x32x16_bf16 v[80:95], v[40:43], v[184:187], v[80:95]
    v_add_u32 v3, 65536, v3
    ds_read_b64_tr_b16 v[40:41], v3 offset:0
    ds_read_b64_tr_b16 v[42:43], v3 offset:512
    v_mul_f32 v51, v51, v67
    v_mul_f32 v52, v52, v68
    v_mul_f32 v53, v53, v69
    v_mul_f32 v54, v54, v70
    v_mfma_f32_32x32x16_bf16 v[80:95], v[44:47], v[188:191], v[80:95]
    v_add_u32 v25, 65536, v25
    ds_read_b64_tr_b16 v[44:45], v25 offset:0
    ds_read_b64_tr_b16 v[46:47], v25 offset:512
    v_mul_f32 v55, v55, v71
    v_mul_f32 v48, v48, v28
    v_mul_f32 v49, v49, v28
    v_mul_f32 v50, v50, v28
    s_waitcnt lgkmcnt(6)
    v_mfma_f32_32x32x16_bf16 v[80:95], v[32:35], v[192:195], v[80:95]
    v_mfma_f32_16x16x32_bf16 v[20:23], v[32:35], v[16:19], v[20:23]
    ds_read_b64_tr_b16 v[32:33], v1 offset:8192
    ds_read_b64_tr_b16 v[34:35], v1 offset:8704
    v_mul_f32 v51, v51, v28
    v_mul_f32 v52, v52, v28
    v_mul_f32 v53, v53, v28
    v_mul_f32 v54, v54, v28
    s_waitcnt lgkmcnt(6)
    v_mfma_f32_32x32x16_bf16 v[80:95], v[36:39], v[196:199], v[80:95]
    ds_read_b64_tr_b16 v[36:37], v2 offset:8192
    ds_read_b64_tr_b16 v[38:39], v2 offset:8704
    v_mul_f32 v55, v55, v28
    v_cvt_pk_bf16_f32 v48, v48, v49
    v_cvt_pk_bf16_f32 v49, v50, v51
    v_cvt_pk_bf16_f32 v50, v52, v53
    s_waitcnt lgkmcnt(6)
    v_mfma_f32_32x32x16_bf16 v[80:95], v[40:43], v[200:203], v[80:95]
    ds_read_b64_tr_b16 v[40:41], v3 offset:8192
    ds_read_b64_tr_b16 v[42:43], v3 offset:8704
    v_cvt_pk_bf16_f32 v51, v54, v55
    buffer_store_dwordx4 v[48:51], v27, s[76:79], s38 offen offset:0 sc1
    v_mul_f32 v56, v56, v72
    v_mul_f32 v57, v57, v73
    s_waitcnt lgkmcnt(6)
    v_mfma_f32_32x32x16_bf16 v[80:95], v[44:47], v[204:207], v[80:95]
    ds_read_b64_tr_b16 v[44:45], v25 offset:8192
    ds_read_b64_tr_b16 v[46:47], v25 offset:8704
    v_mul_f32 v58, v58, v74
    v_mul_f32 v59, v59, v75
    v_mul_f32 v60, v60, v76
    v_mul_f32 v61, v61, v77
    s_waitcnt lgkmcnt(6)
    v_mfma_f32_32x32x16_bf16 v[80:95], v[32:35], v[208:211], v[80:95]
    v_mfma_f32_16x16x32_bf16 v[20:23], v[32:35], v[16:19], v[20:23]
    s_waitcnt lgkmcnt(0)
    s_waitcnt vmcnt(15)
    s_barrier
    ds_read_b64_tr_b16 v[32:33], v1 offset:16384
    ds_read_b64_tr_b16 v[34:35], v1 offset:16896
    v_mul_f32 v62, v62, v78
    v_mul_f32 v63, v63, v79
    v_mul_f32 v56, v56, v28
    v_mul_f32 v57, v57, v28
    v_mfma_f32_32x32x16_bf16 v[80:95], v[36:39], v[212:215], v[80:95]
    ds_read_b64_tr_b16 v[36:37], v2 offset:16384
    ds_read_b64_tr_b16 v[38:39], v2 offset:16896
    s_add_u32 m0, s30, 81920
    s_nop 0
    buffer_load_dwordx4 v9, s[64:67], s22 offen lds
    s_add_u32 m0, s30, 90112
    s_nop 0
    buffer_load_dwordx4 v9, s[68:71], s22 offen lds
    s_add_u32 s22, s22, 196608
    s_cmp_eq_u32 s22, 1966080
    s_cselect_b32 s22, 0, s22
    v_mul_f32 v58, v58, v28
    v_mul_f32 v59, v59, v28
    v_mul_f32 v60, v60, v28
    v_mul_f32 v61, v61, v28
    v_mfma_f32_32x32x16_bf16 v[80:95], v[40:43], v[216:219], v[80:95]
    ds_read_b64_tr_b16 v[40:41], v3 offset:16384
    ds_read_b64_tr_b16 v[42:43], v3 offset:16896
    v_mul_f32 v62, v62, v28
    v_mul_f32 v63, v63, v28
    v_cvt_pk_bf16_f32 v56, v56, v57
    v_cvt_pk_bf16_f32 v57, v58, v59
    v_mfma_f32_32x32x16_bf16 v[80:95], v[44:47], v[220:223], v[80:95]
    ds_read_b64_tr_b16 v[44:45], v25 offset:16384
    ds_read_b64_tr_b16 v[46:47], v25 offset:16896
    v_cvt_pk_bf16_f32 v58, v60, v61
    v_cvt_pk_bf16_f32 v59, v62, v63
    buffer_store_dwordx4 v[56:59], v27, s[76:79], s38 offen offset:1024 sc1
    s_waitcnt lgkmcnt(6)
    v_mfma_f32_32x32x16_bf16 v[80:95], v[32:35], v[224:227], v[80:95]
    v_mfma_f32_16x16x32_bf16 v[20:23], v[32:35], v[16:19], v[20:23]
    ds_read_b64_tr_b16 v[32:33], v1 offset:24576
    ds_read_b64_tr_b16 v[34:35], v1 offset:25088
    s_waitcnt lgkmcnt(6)
    v_mfma_f32_32x32x16_bf16 v[80:95], v[36:39], v[228:231], v[80:95]
    ds_read_b64_tr_b16 v[36:37], v2 offset:24576
    ds_read_b64_tr_b16 v[38:39], v2 offset:25088
    s_waitcnt lgkmcnt(6)
    v_mfma_f32_32x32x16_bf16 v[80:95], v[40:43], v[232:235], v[80:95]
    ds_read_b64_tr_b16 v[40:41], v3 offset:24576
    ds_read_b64_tr_b16 v[42:43], v3 offset:25088
    s_waitcnt lgkmcnt(6)
    v_mfma_f32_32x32x16_bf16 v[80:95], v[44:47], v[236:239], v[80:95]
    ds_read_b64_tr_b16 v[44:45], v25 offset:24576
    ds_read_b64_tr_b16 v[46:47], v25 offset:25088
    s_waitcnt lgkmcnt(6)
    v_mfma_f32_32x32x16_bf16 v[80:95], v[32:35], v[240:243], v[80:95]
    v_mfma_f32_16x16x32_bf16 v[20:23], v[32:35], v[16:19], v[20:23]
    s_waitcnt lgkmcnt(0)
    s_waitcnt vmcnt(16)
    s_barrier
    ds_read_b64_tr_b16 v[32:33], v1 offset:32768
    ds_read_b64_tr_b16 v[34:35], v1 offset:33280
    v_mfma_f32_32x32x16_bf16 v[80:95], v[36:39], v[244:247], v[80:95]
    ds_read_b64_tr_b16 v[36:37], v1 offset:40960
    ds_read_b64_tr_b16 v[38:39], v1 offset:41472
    s_add_u32 m0, s30, 98304
    s_nop 0
    buffer_load_dwordx4 v9, s[64:67], s22 offen lds
    s_add_u32 m0, s30, 106496
    s_nop 0
    buffer_load_dwordx4 v9, s[68:71], s22 offen lds
    s_add_u32 s22, s22, 196608
    s_cmp_eq_u32 s22, 1966080
    s_cselect_b32 s22, 0, s22
    v_mfma_f32_32x32x16_bf16 v[80:95], v[40:43], v[248:251], v[80:95]
    ds_read_b64_tr_b16 v[40:41], v2 offset:32768
    ds_read_b64_tr_b16 v[42:43], v2 offset:33280
    v_mfma_f32_32x32x16_bf16 v[80:95], v[44:47], v[252:255], v[80:95]
    ds_read_b64_tr_b16 v[44:45], v2 offset:40960
    ds_read_b64_tr_b16 v[46:47], v2 offset:41472
    v_and_b32 v30, 0x31, v0
    v_mul_u32_u24 v30, 0x104, v30
    v_and_b32 v30, 0x1c0, v30
    v_add_u32 v30, s3, v30
    s_nop 4
    ds_write_b32 v30, v20 offset:4096
    ds_write_b32 v30, v21 offset:4112
    ds_write_b32 v30, v22 offset:4128
    ds_write_b32 v30, v23 offset:4144
    s_branch K1J_2
K1Y_1:
    s_waitcnt lgkmcnt(15)
    v_mfma_f32_32x32x16_bf16 v[80:95], v[32:35], v[96:99], 0
    v_mfma_f32_16x16x32_bf16 v[20:23], v[32:35], v[16:19], 0
    ds_read_b64_tr_b16 v[32:33], v1 offset:24576
    ds_read_b64_tr_b16 v[34:35], v1 offset:25088
    s_waitcnt lgkmcnt(15)
    v_mfma_f32_32x32x16_bf16 v[80:95], v[36:39], v[100:103], v[80:95]
    ds_read_b64_tr_b16 v[36:37], v2 offset:24576
    ds_read_b64_tr_b16 v[38:39], v2 offset:25088
    s_waitcnt lgkmcnt(15)
    v_mfma_f32_32x32x16_bf16 v[80:95], v[40:43], v[104:107], v[80:95]
    ds_read_b64_tr_b16 v[40:41], v3 offset:24576
    ds_read_b64_tr_b16 v[42:43], v3 offset:25088
    s_waitcnt lgkmcnt(15)
    v_mfma_f32_32x32x16_bf16 v[80:95], v[44:47], v[108:111], v[80:95]
    ds_read_b64_tr_b16 v[44:45], v25 offset:24576
    ds_read_b64_tr_b16 v[46:47], v25 offset:25088
    s_waitcnt lgkmcnt(6)
    v_mfma_f32_32x32x16_bf16 v[80:95], v[32:35], v[112:115], v[80:95]
    v_mfma_f32_16x16x32_bf16 v[20:23], v[32:35], v[16:19], v[20:23]
    s_waitcnt lgkmcnt(0)
    s_waitcnt vmcnt(14)
    s_barrier
    ds_read_b64_tr_b16 v[32:33], v1 offset:32768
    ds_read_b64_tr_b16 v[34:35], v1 offset:33280
    v_mfma_f32_32x32x16_bf16 v[80:95], v[36:39], v[116:119], v[80:95]
    ds_read_b64_tr_b16 v[36:37], v2 offset:32768
    ds_read_b64_tr_b16 v[38:39], v2 offset:33280
    s_add_u32 m0, s30, 32768
    s_nop 0
    buffer_load_dwordx4 v9, s[64:67], s22 offen lds
    s_add_u32 m0, s30, 40960
    s_nop 0
    buffer_load_dwordx4 v9, s[68:71], s22 offen lds
    s_add_u32 s22, s22, 196608
    s_cmp_eq_u32 s22, 1966080
    s_cselect_b32 s22, 0, s22
    v_lshl_add_u32 v30, v0, 3, s10
    v_add_u32 v30, s11, v30
    v_xor_b32 v30, 512, v30
    ds_read_b64 v[4:5], v30
    v_mfma_f32_32x32x16_bf16 v[80:95], v[40:43], v[120:123], v[80:95]
    ds_read_b64_tr_b16 v[40:41], v3 offset:32768
    ds_read_b64_tr_b16 v[42:43], v3 offset:33280
    s_waitcnt lgkmcnt(2)
    v_mfma_f32_32x32x16_bf16 v[80:95], v[44:47], v[124:127], v[80:95]
    ds_read_b64_tr_b16 v[44:45], v25 offset:32768
    ds_read_b64_tr_b16 v[46:47], v25 offset:33280
    v_add_f32 v14, v10, v4
    v_add_f32 v15, v11, v5
    v_mov_b32 v4, v14
    v_mov_b32 v5, v15
    v_mfma_f32_32x32x16_bf16 v[80:95], v[32:35], v[128:131], v[80:95]
    v_mfma_f32_16x16x32_bf16 v[20:23], v[32:35], v[16:19], v[20:23]
    ds_read_b64_tr_b16 v[32:33], v1 offset:40960
    ds_read_b64_tr_b16 v[34:35], v1 offset:41472
    s_nop 1
    v_permlane32_swap_b32 v14, v4
    v_permlane32_swap_b32 v15, v5
    v_add_f32 v14, v14, v4
    v_add_f32 v15, v15, v5
    v_mul_f32 v14, 0xbacccccd, v14
    v_mfma_f32_32x32x16_bf16 v[80:95], v[36:39], v[132:135], v[80:95]
    ds_read_b64_tr_b16 v[36:37], v2 offset:40960
    ds_read_b64_tr_b16 v[38:39], v2 offset:41472
    v_mul_f32 v15, 0x3acccccd, v15
    v_fma_f32 v15, -v14, v14, v15
    v_max_f32 v15, 0, v15
    v_mul_f32 v14, 0.5, v14
    s_waitcnt lgkmcnt(6)
    v_mfma_f32_32x32x16_bf16 v[80:95], v[40:43], v[136:139], v[80:95]
    ds_read_b64_tr_b16 v[40:41], v3 offset:40960
    ds_read_b64_tr_b16 v[42:43], v3 offset:41472
    v_add_f32 v15, 0x3727c5ac, v15
    v_rsq_f32 v24, v15
    v_cvt_pk_bf16_f32 v10, v14, v14
    v_and_b32 v4, s93, v10
    s_waitcnt lgkmcnt(6)
    v_mfma_f32_32x32x16_bf16 v[80:95], v[44:47], v[140:143], v[80:95]
    ds_read_b64_tr_b16 v[44:45], v25 offset:40960
    ds_read_b64_tr_b16 v[46:47], v25 offset:41472
    v_sub_f32 v4, v14, v4
    v_cvt_pk_bf16_f32 v11, v4, v4
    v_mul_f32 v28, v24, v24
    ds_read_b128 v[4:7], v31 offset:0
    s_waitcnt lgkmcnt(7)
    v_mfma_f32_32x32x16_bf16 v[80:95], v[32:35], v[144:147], v[80:95]
    v_mfma_f32_16x16x32_bf16 v[20:23], v[32:35], v[16:19], v[20:23]
    s_waitcnt lgkmcnt(0)
    s_waitcnt vmcnt(14)
    s_barrier
    ds_read_b64_tr_b16 v[32:33], v1 offset:49152
    ds_read_b64_tr_b16 v[34:35], v1 offset:49664
    v_mfma_f32_32x32x16_bf16 v[80:95], v[36:39], v[148:151], v[80:95]
    ds_read_b64_tr_b16 v[36:37], v2 offset:49152
    ds_read_b64_tr_b16 v[38:39], v2 offset:49664
    s_add_u32 m0, s30, 49152
    s_nop 0
    buffer_load_dwordx4 v9, s[64:67], s22 offen lds
    s_add_u32 m0, s30, 57344
    s_nop 0
    buffer_load_dwordx4 v9, s[68:71], s22 offen lds
    s_add_u32 s22, s22, 196608
    s_cmp_eq_u32 s22, 1966080
    s_cselect_b32 s22, 0, s22
    v_add_f32 v4, v4, v5
    v_mfma_f32_32x32x16_bf16 v[80:95], v[40:43], v[152:155], v[80:95]
    ds_read_b64_tr_b16 v[40:41], v3 offset:49152
    ds_read_b64_tr_b16 v[42:43], v3 offset:49664
    v_add_f32 v6, v6, v7
    v_add_f32 v4, v4, v6
    v_cvt_pk_bf16_f32 v6, v4, v4
    v_and_b32 v6, s93, v6
    v_mfma_f32_32x32x16_bf16 v[80:95], v[44:47], v[156:159], v[80:95]
    ds_read_b64_tr_b16 v[44:45], v25 offset:49152
    ds_read_b64_tr_b16 v[46:47], v25 offset:49664
    v_sub_f32 v7, v4, v6
    v_cvt_pk_bf16_f32 v6, v4, v7
    v_cvt_pk_bf16_f32 v7, v4, v7
    s_nop 1
    v_mfma_f32_32x32x8bf16_1k v[48:63], v[6:7], v[10:11], v[48:63]
    ds_read_b128 v[4:7], v31 offset:2048
    s_waitcnt lgkmcnt(7)
    v_mfma_f32_32x32x16_bf16 v[80:95], v[32:35], v[160:163], v[80:95]
    v_mfma_f32_16x16x32_bf16 v[20:23], v[32:35], v[16:19], v[20:23]
    ds_read_b64_tr_b16 v[32:33], v1 offset:57344
    ds_read_b64_tr_b16 v[34:35], v1 offset:57856
    s_waitcnt lgkmcnt(7)
    v_mfma_f32_32x32x16_bf16 v[80:95], v[36:39], v[164:167], v[80:95]
    ds_read_b64_tr_b16 v[36:37], v2 offset:57344
    ds_read_b64_tr_b16 v[38:39], v2 offset:57856
    s_waitcnt lgkmcnt(4)
    v_add_f32 v4, v4, v5
    v_add_f32 v6, v6, v7
    v_mfma_f32_32x32x16_bf16 v[80:95], v[40:43], v[168:171], v[80:95]
    ds_read_b64_tr_b16 v[40:41], v3 offset:57344
    ds_read_b64_tr_b16 v[42:43], v3 offset:57856
    v_add_f32 v4, v4, v6
    v_cvt_pk_bf16_f32 v6, v4, v4
    v_and_b32 v6, s93, v6
    v_sub_f32 v7, v4, v6
    v_mfma_f32_32x32x16_bf16 v[80:95], v[44:47], v[172:175], v[80:95]
    ds_read_b64_tr_b16 v[44:45], v25 offset:57344
    ds_read_b64_tr_b16 v[46:47], v25 offset:57856
    v_cvt_pk_bf16_f32 v6, v4, v7
    v_cvt_pk_bf16_f32 v7, v4, v7
    s_nop 1
    v_mfma_f32_32x32x8bf16_1k v[64:79], v[6:7], v[10:11], v[64:79]
    s_waitcnt lgkmcnt(6)
    v_mfma_f32_32x32x16_bf16 v[80:95], v[32:35], v[176:179], v[80:95]
    v_mfma_f32_16x16x32_bf16 v[20:23], v[32:35], v[16:19], v[20:23]
    s_waitcnt lgkmcnt(0)
    s_waitcnt vmcnt(14)
    s_barrier
    v_add_u32 v1, 65536, v1
    ds_read_b64_tr_b16 v[32:33], v1 offset:0
    ds_read_b64_tr_b16 v[34:35], v1 offset:512
    v_mfma_f32_32x32x16_bf16 v[80:95], v[36:39], v[180:183], v[80:95]
    v_add_u32 v2, 65536, v2
    ds_read_b64_tr_b16 v[36:37], v2 offset:0
    ds_read_b64_tr_b16 v[38:39], v2 offset:512
    s_add_u32 m0, s30, 65536
    s_nop 0
    buffer_load_dwordx4 v9, s[64:67], s22 offen lds
    s_add_u32 m0, s30, 73728
    s_nop 0
    buffer_load_dwordx4 v9, s[68:71], s22 offen lds
    s_add_u32 s22, s22, 196608
    s_cmp_eq_u32 s22, 1966080
    s_cselect_b32 s22, 0, s22
    v_mul_f32 v14, s42, v24
    v_mul_f32 v48, v48, v14
    v_mul_f32 v49, v49, v14
    v_mfma_f32_32x32x16_bf16 v[80:95], v[40:43], v[184:187], v[80:95]
    v_add_u32 v3, 65536, v3
    ds_read_b64_tr_b16 v[40:41], v3 offset:0
    ds_read_b64_tr_b16 v[42:43], v3 offset:512
    v_mul_f32 v50, v50, v14
    v_mul_f32 v51, v51, v14
    v_cvt_pk_bf16_f32 v48, v48, v49
    v_cvt_pk_bf16_f32 v49, v50, v51
    v_mfma_f32_32x32x16_bf16 v[80:95], v[44:47], v[188:191], v[80:95]
    v_add_u32 v25, 65536, v25
    ds_read_b64_tr_b16 v[44:45], v25 offset:0
    ds_read_b64_tr_b16 v[46:47], v25 offset:512
    buffer_store_dwordx2 v[48:49], v26, s[72:75], s38 offen offset:0 sc1
    v_mul_f32 v52, v52, v14
    v_mul_f32 v53, v53, v14
    v_mul_f32 v54, v54, v14
    s_waitcnt lgkmcnt(6)
    v_mfma_f32_32x32x16_bf16 v[80:95], v[32:35], v[192:195], v[80:95]
    v_mfma_f32_16x16x32_bf16 v[20:23], v[32:35], v[16:19], v[20:23]
    ds_read_b64_tr_b16 v[32:33], v1 offset:8192
    ds_read_b64_tr_b16 v[34:35], v1 offset:8704
    v_mul_f32 v55, v55, v14
    v_cvt_pk_bf16_f32 v52, v52, v53
    v_cvt_pk_bf16_f32 v53, v54, v55
    buffer_store_dwordx2 v[52:53], v26, s[72:75], s38 offen offset:512 sc1
    s_waitcnt lgkmcnt(6)
    v_mfma_f32_32x32x16_bf16 v[80:95], v[36:39], v[196:199], v[80:95]
    ds_read_b64_tr_b16 v[36:37], v2 offset:8192
    ds_read_b64_tr_b16 v[38:39], v2 offset:8704
    v_mul_f32 v56, v56, v14
    v_mul_f32 v57, v57, v14
    v_mul_f32 v58, v58, v14
    v_mul_f32 v59, v59, v14
    s_waitcnt lgkmcnt(6)
    v_mfma_f32_32x32x16_bf16 v[80:95], v[40:43], v[200:203], v[80:95]
    ds_read_b64_tr_b16 v[40:41], v3 offset:8192
    ds_read_b64_tr_b16 v[42:43], v3 offset:8704
    v_cvt_pk_bf16_f32 v56, v56, v57
    v_cvt_pk_bf16_f32 v57, v58, v59
    buffer_store_dwordx2 v[56:57], v26, s[72:75], s38 offen offset:1024 sc1
    v_mul_f32 v60, v60, v14
    s_waitcnt lgkmcnt(6)
    v_mfma_f32_32x32x16_bf16 v[80:95], v[44:47], v[204:207], v[80:95]
    ds_read_b64_tr_b16 v[44:45], v25 offset:8192
    ds_read_b64_tr_b16 v[46:47], v25 offset:8704
    v_mul_f32 v61, v61, v14
    v_mul_f32 v62, v62, v14
    v_mul_f32 v63, v63, v14
    v_cvt_pk_bf16_f32 v60, v60, v61
    s_waitcnt lgkmcnt(6)
    v_mfma_f32_32x32x16_bf16 v[80:95], v[32:35], v[208:211], v[80:95]
    v_mfma_f32_16x16x32_bf16 v[20:23], v[32:35], v[16:19], v[20:23]
    s_waitcnt lgkmcnt(0)
    s_waitcnt vmcnt(17)
    s_barrier
    ds_read_b64_tr_b16 v[32:33], v1 offset:16384
    ds_read_b64_tr_b16 v[34:35], v1 offset:16896
    v_cvt_pk_bf16_f32 v61, v62, v63
    buffer_store_dwordx2 v[60:61], v26, s[72:75], s38 offen offset:1536 sc1
    v_mul_f32 v14, s43, v24
    v_mul_f32 v64, v64, v14
    v_mfma_f32_32x32x16_bf16 v[80:95], v[36:39], v[212:215], v[80:95]
    ds_read_b64_tr_b16 v[36:37], v2 offset:16384
    ds_read_b64_tr_b16 v[38:39], v2 offset:16896
    s_add_u32 m0, s30, 81920
    s_nop 0
    buffer_load_dwordx4 v9, s[64:67], s22 offen lds
    s_add_u32 m0, s30, 90112
    s_nop 0
    buffer_load_dwordx4 v9, s[68:71], s22 offen lds
    s_add_u32 s22, s22, 196608
    s_cmp_eq_u32 s22, 1966080
    s_cselect_b32 s22, 0, s22
    v_mul_f32 v65, v65, v14
    v_mul_f32 v66, v66, v14
    v_mul_f32 v67, v67, v14
    v_cvt_pk_bf16_f32 v64, v64, v65
    v_mfma_f32_32x32x16_bf16 v[80:95], v[40:43], v[216:219], v[80:95]
    ds_read_b64_tr_b16 v[40:41], v3 offset:16384
    ds_read_b64_tr_b16 v[42:43], v3 offset:16896
    v_cvt_pk_bf16_f32 v65, v66, v67
    buffer_store_dwordx2 v[64:65], v26, s[72:75], s39 offen offset:0 sc1
    v_mul_f32 v68, v68, v14
    v_mul_f32 v69, v69, v14
    v_mfma_f32_32x32x16_bf16 v[80:95], v[44:47], v[220:223], v[80:95]
    ds_read_b64_tr_b16 v[44:45], v25 offset:16384
    ds_read_b64_tr_b16 v[46:47], v25 offset:16896
    v_mul_f32 v70, v70, v14
    v_mul_f32 v71, v71, v14
    v_cvt_pk_bf16_f32 v68, v68, v69
    v_cvt_pk_bf16_f32 v69, v70, v71
    s_waitcnt lgkmcnt(6)
    v_mfma_f32_32x32x16_bf16 v[80:95], v[32:35], v[224:227], v[80:95]
    v_mfma_f32_16x16x32_bf16 v[20:23], v[32:35], v[16:19], v[20:23]
    ds_read_b64_tr_b16 v[32:33], v1 offset:24576
    ds_read_b64_tr_b16 v[34:35], v1 offset:25088
    buffer_store_dwordx2 v[68:69], v26, s[72:75], s39 offen offset:512 sc1
    v_mul_f32 v72, v72, v14
    v_mul_f32 v73, v73, v14
    v_mul_f32 v74, v74, v14
    s_waitcnt lgkmcnt(6)
    v_mfma_f32_32x32x16_bf16 v[80:95], v[36:39], v[228:231], v[80:95]
    ds_read_b64_tr_b16 v[36:37], v2 offset:24576
    ds_read_b64_tr_b16 v[38:39], v2 offset:25088
    v_mul_f32 v75, v75, v14
    v_cvt_pk_bf16_f32 v72, v72, v73
    v_cvt_pk_bf16_f32 v73, v74, v75
    buffer_store_dwordx2 v[72:73], v26, s[72:75], s39 offen offset:1024 sc1
    s_waitcnt lgkmcnt(6)
    v_mfma_f32_32x32x16_bf16 v[80:95], v[40:43], v[232:235], v[80:95]
    ds_read_b64_tr_b16 v[40:41], v3 offset:24576
    ds_read_b64_tr_b16 v[42:43], v3 offset:25088
    v_mul_f32 v76, v76, v14
    v_mul_f32 v77, v77, v14
    v_mul_f32 v78, v78, v14
    v_mul_f32 v79, v79, v14
    s_waitcnt lgkmcnt(6)
    v_mfma_f32_32x32x16_bf16 v[80:95], v[44:47], v[236:239], v[80:95]
    ds_read_b64_tr_b16 v[44:45], v25 offset:24576
    ds_read_b64_tr_b16 v[46:47], v25 offset:25088
    v_cvt_pk_bf16_f32 v76, v76, v77
    v_cvt_pk_bf16_f32 v77, v78, v79
    buffer_store_dwordx2 v[76:77], v26, s[72:75], s39 offen offset:1536 sc1
    s_waitcnt lgkmcnt(6)
    v_mfma_f32_32x32x16_bf16 v[80:95], v[32:35], v[240:243], v[80:95]
    v_mfma_f32_16x16x32_bf16 v[20:23], v[32:35], v[16:19], v[20:23]
    s_waitcnt lgkmcnt(0)
    s_waitcnt vmcnt(22)
    s_barrier
    ds_read_b64_tr_b16 v[32:33], v1 offset:32768
    ds_read_b64_tr_b16 v[34:35], v1 offset:33280
    v_mfma_f32_32x32x16_bf16 v[80:95], v[36:39], v[244:247], v[80:95]
    ds_read_b64_tr_b16 v[36:37], v1 offset:40960
    ds_read_b64_tr_b16 v[38:39], v1 offset:41472
    s_add_u32 m0, s30, 98304
    s_nop 0
    buffer_load_dwordx4 v9, s[64:67], s22 offen lds
    s_add_u32 m0, s30, 106496
    s_nop 0
    buffer_load_dwordx4 v9, s[68:71], s22 offen lds
    s_add_u32 s22, s22, 196608
    s_cmp_eq_u32 s22, 1966080
    s_cselect_b32 s22, 0, s22
    v_mfma_f32_32x32x16_bf16 v[80:95], v[40:43], v[248:251], v[80:95]
    ds_read_b64_tr_b16 v[40:41], v2 offset:32768
    ds_read_b64_tr_b16 v[42:43], v2 offset:33280
    v_mfma_f32_32x32x16_bf16 v[80:95], v[44:47], v[252:255], v[80:95]
    ds_read_b64_tr_b16 v[44:45], v2 offset:40960
    ds_read_b64_tr_b16 v[46:47], v2 offset:41472
    v_and_b32 v30, 0x31, v0
    v_mul_u32_u24 v30, 0x104, v30
    v_and_b32 v30, 0x1c0, v30
    v_add_u32 v30, s3, v30
    s_nop 4
    ds_write_b32 v30, v20 offset:4096
    ds_write_b32 v30, v21 offset:4112
    ds_write_b32 v30, v22 offset:4128
    ds_write_b32 v30, v23 offset:4144
K1J_2:
    s_waitcnt lgkmcnt(0)
    v_mfma_f32_32x32x16_bf16 v[48:63], v[32:35], v[96:99], 0
    v_mfma_f32_16x16x32_bf16 v[20:23], v[32:35], v[16:19], 0
    ds_read_b64_tr_b16 v[32:33], v3 offset:32768
    ds_read_b64_tr_b16 v[34:35], v3 offset:33280
    v_lshrrev_b32 v4, 3, v0
    v_and_b32 v5, 7, v0
    v_lshlrev_b32 v5, 4, v5
    v_mfma_f32_32x32x16_bf16 v[64:79], v[36:39], v[96:99], 0
    ds_read_b64_tr_b16 v[36:37], v3 offset:40960
    ds_read_b64_tr_b16 v[38:39], v3 offset:41472
    v_mul_u32_u24 v4, 1280, v4
    v_add_u32 v4, v4, v5
    v_lshrrev_b32 v5, 5, v0
    v_mfma_f32_32x32x16_bf16 v[48:63], v[40:43], v[100:103], v[48:63]
    ds_read_b64_tr_b16 v[40:41], v25 offset:32768
    ds_read_b64_tr_b16 v[42:43], v25 offset:33280
    v_bfe_u32 v6, v0, 4, 1
    v_mul_u32_u24 v6, s90, v6
    v_lshl_add_u32 v5, v5, 4, v6
    v_mfma_f32_32x32x16_bf16 v[64:79], v[44:47], v[100:103], v[64:79]
    ds_read_b64_tr_b16 v[44:45], v25 offset:40960
    ds_read_b64_tr_b16 v[46:47], v25 offset:41472
    v_bfe_u32 v6, v0, 2, 2
    v_add_u32 v5, v5, v6
    v_lshlrev_b32 v5, 7, v5
    s_waitcnt lgkmcnt(6)
    v_mfma_f32_32x32x16_bf16 v[48:63], v[32:35], v[104:107], v[48:63]
    s_waitcnt lgkmcnt(0)
    s_waitcnt vmcnt(14)
    s_barrier
    ds_read_b64_tr_b16 v[32:33], v1 offset:49152
    ds_read_b64_tr_b16 v[34:35], v1 offset:49664
    v_and_b32 v6, 3, v0
    v_lshl_add_u32 v5, v6, 3, v5
    v_add_u32 v5, s92, v5
    v_mfma_f32_32x32x16_bf16 v[64:79], v[36:39], v[104:107], v[64:79]
    v_mfma_f32_16x16x32_bf16 v[12:15], v[36:39], v[16:19], 0
    ds_read_b64_tr_b16 v[36:37], v1 offset:57344
    ds_read_b64_tr_b16 v[38:39], v1 offset:57856
    s_add_u32 m0, s30, 114688
    s_nop 0
    buffer_load_dwordx4 v9, s[64:67], s22 offen lds
    s_add_u32 m0, s30, 122880
    s_nop 0
    buffer_load_dwordx4 v9, s[68:71], s22 offen lds
    s_add_u32 s22, s22, 196608
    s_cmp_eq_u32 s22, 1966080
    s_cselect_b32 s22, 0, s22
    v_add_u32 v6, s91, v5
    v_lshlrev_b32 v7, 4, v0
    v_mfma_f32_32x32x16_bf16 v[48:63], v[40:43], v[108:111], v[48:63]
    ds_read_b64_tr_b16 v[40:41], v2 offset:49152
    ds_read_b64_tr_b16 v[42:43], v2 offset:49664
    ds_read_b128 v[96:99], v31 offset:4096
    v_mfma_f32_32x32x16_bf16 v[64:79], v[44:47], v[108:111], v[64:79]
    ds_read_b64_tr_b16 v[44:45], v2 offset:57344
    ds_read_b64_tr_b16 v[46:47], v2 offset:57856
    s_waitcnt lgkmcnt(7)
    v_mfma_f32_32x32x16_bf16 v[48:63], v[32:35], v[112:115], v[48:63]
    v_mfma_f32_16x16x32_bf16 v[20:23], v[32:35], v[16:19], v[20:23]
    ds_read_b64_tr_b16 v[32:33], v3 offset:49152
    ds_read_b64_tr_b16 v[34:35], v3 offset:49664
    s_waitcnt lgkmcnt(4)
    v_add_f32 v96, v96, v97
    v_mfma_f32_32x32x16_bf16 v[64:79], v[36:39], v[112:115], v[64:79]
    ds_read_b64_tr_b16 v[36:37], v3 offset:57344
    ds_read_b64_tr_b16 v[38:39], v3 offset:57856
    v_add_f32 v98, v98, v99
    v_add_f32 v96, v96, v98
    v_cvt_pk_bf16_f32 v98, v96, v96
    v_mfma_f32_32x32x16_bf16 v[48:63], v[40:43], v[116:119], v[48:63]
    ds_read_b64_tr_b16 v[40:41], v25 offset:49152
    ds_read_b64_tr_b16 v[42:43], v25 offset:49664
    v_and_b32 v98, s93, v98
    v_sub_f32 v99, v96, v98
    v_cvt_pk_bf16_f32 v98, v96, v99
    v_cvt_pk_bf16_f32 v99, v96, v99
    s_nop 1
    v_mfma_f32_32x32x8bf16_1k v[80:95], v[98:99], v[10:11], v[80:95]
    s_waitcnt lgkmcnt(6)
    v_mfma_f32_32x32x16_bf16 v[64:79], v[44:47], v[116:119], v[64:79]
    ds_read_b64_tr_b16 v[44:45], v25 offset:57344
    ds_read_b64_tr_b16 v[46:47], v25 offset:57856
    s_waitcnt lgkmcnt(6)
    v_mfma_f32_32x32x16_bf16 v[48:63], v[32:35], v[120:123], v[48:63]
    s_waitcnt lgkmcnt(0)
    s_waitcnt vmcnt(14)
    s_barrier
    v_add_u32 v1, 4294885376, v1
    ds_read_b64_tr_b16 v[32:33], v1 offset:0
    ds_read_b64_tr_b16 v[34:35], v1 offset:512
    v_mfma_f32_32x32x16_bf16 v[64:79], v[36:39], v[120:123], v[64:79]
    v_mfma_f32_16x16x32_bf16 v[12:15], v[36:39], v[16:19], v[12:15]
    ds_read_b64_tr_b16 v[36:37], v1 offset:8192
    ds_read_b64_tr_b16 v[38:39], v1 offset:8704
    s_cmp_ge_u32 s89, 680
    s_cbranch_scc1 K1S_3
    s_add_u32 m0, s92, 0
    s_mov_b32 s33, 0
    buffer_load_dwordx4 v4, s[80:83], s33 offen lds
    s_add_u32 m0, s92, 1024
    s_mov_b32 s33, 10240
    buffer_load_dwordx4 v4, s[80:83], s33 offen lds
    s_add_u32 m0, s92, 2048
    s_mov_b32 s33, 20480
    buffer_load_dwordx4 v4, s[80:83], s33 offen lds
    s_add_u32 m0, s92, 3072
    s_mov_b32 s33, 30720
    buffer_load_dwordx4 v4, s[80:83], s33 offen lds
K1S_3:
    v_mul_f32 v96, s44, v24
    v_mfma_f32_32x32x16_bf16 v[48:63], v[40:43], v[124:127], v[48:63]
    v_add_u32 v2, 4294885376, v2
    ds_read_b64_tr_b16 v[40:41], v2 offset:0
    ds_read_b64_tr_b16 v[42:43], v2 offset:512
    v_mul_f32 v80, v80, v96
    v_mul_f32 v81, v81, v96
    v_mul_f32 v82, v82, v96
    v_mfma_f32_32x32x16_bf16 v[64:79], v[44:47], v[124:127], v[64:79]
    ds_read_b64_tr_b16 v[44:45], v2 offset:8192
    ds_read_b64_tr_b16 v[46:47], v2 offset:8704
    v_mul_f32 v83, v83, v96
    v_cvt_pk_bf16_f32 v80, v80, v81
    v_cvt_pk_bf16_f32 v81, v82, v83
    s_waitcnt lgkmcnt(6)
    v_mfma_f32_32x32x16_bf16 v[48:63], v[32:35], v[128:131], v[48:63]
    v_mfma_f32_16x16x32_bf16 v[20:23], v[32:35], v[16:19], v[20:23]
    v_add_u32 v3, 4294885376, v3
    ds_read_b64_tr_b16 v[32:33], v3 offset:0
    ds_read_b64_tr_b16 v[34:35], v3 offset:512
    s_mov_b64 exec, s[96:97]
    buffer_store_dwordx2 v[80:81], v26, s[72:75], s40 offen offset:0 sc1
    s_mov_b64 exec, -1
    v_mul_f32 v84, v84, v96
    v_mul_f32 v85, v85, v96
    s_waitcnt lgkmcnt(6)
    v_mfma_f32_32x32x16_bf16 v[64:79], v[36:39], v[128:131], v[64:79]
    ds_read_b64_tr_b16 v[36:37], v3 offset:8192
    ds_read_b64_tr_b16 v[38:39], v3 offset:8704
    v_mul_f32 v86, v86, v96
    v_mul_f32 v87, v87, v96
    v_cvt_pk_bf16_f32 v84, v84, v85
    s_waitcnt lgkmcnt(6)
    v_mfma_f32_32x32x16_bf16 v[48:63], v[40:43], v[132:135], v[48:63]
    v_add_u32 v25, 4294885376, v25
    ds_read_b64_tr_b16 v[40:41], v25 offset:0
    ds_read_b64_tr_b16 v[42:43], v25 offset:512
    v_cvt_pk_bf16_f32 v85, v86, v87
    s_mov_b64 exec, s[96:97]
    buffer_store_dwordx2 v[84:85], v26, s[72:75], s40 offen offset:512 sc1
    s_mov_b64 exec, -1
    v_mul_f32 v88, v88, v96
    s_waitcnt lgkmcnt(6)
    v_mfma_f32_32x32x16_bf16 v[64:79], v[44:47], v[132:135], v[64:79]
    ds_read_b64_tr_b16 v[44:45], v25 offset:8192
    ds_read_b64_tr_b16 v[46:47], v25 offset:8704
    v_mul_f32 v89, v89, v96
    v_mul_f32 v90, v90, v96
    v_mul_f32 v91, v91, v96
    s_waitcnt lgkmcnt(6)
    v_mfma_f32_32x32x16_bf16 v[48:63], v[32:35], v[136:139], v[48:63]
    s_waitcnt lgkmcnt(0)
    s_waitcnt vmcnt(14)
    s_barrier
    ds_read_b64_tr_b16 v[32:33], v1 offset:16384
    ds_read_b64_tr_b16 v[34:35], v1 offset:16896
    v_cvt_pk_bf16_f32 v88, v88, v89
    v_cvt_pk_bf16_f32 v89, v90, v91
    s_mov_b64 exec, s[96:97]
    buffer_store_dwordx2 v[88:89], v26, s[72:75], s40 offen offset:1024 sc1
    s_mov_b64 exec, -1
    v_mfma_f32_32x32x16_bf16 v[64:79], v[36:39], v[136:139], v[64:79]
    v_mfma_f32_16x16x32_bf16 v[12:15], v[36:39], v[16:19], v[12:15]
    ds_read_b64_tr_b16 v[36:37], v1 offset:24576
    ds_read_b64_tr_b16 v[38:39], v1 offset:25088
    v_mul_f32 v92, v92, v96
    v_mul_f32 v93, v93, v96
    v_mul_f32 v94, v94, v96
    v_mfma_f32_32x32x16_bf16 v[48:63], v[40:43], v[140:143], v[48:63]
    ds_read_b64_tr_b16 v[40:41], v2 offset:16384
    ds_read_b64_tr_b16 v[42:43], v2 offset:16896
    v_mul_f32 v95, v95, v96
    v_cvt_pk_bf16_f32 v92, v92, v93
    v_cvt_pk_bf16_f32 v93, v94, v95
    v_mfma_f32_32x32x16_bf16 v[64:79], v[44:47], v[140:143], v[64:79]
    ds_read_b64_tr_b16 v[44:45], v2 offset:24576
    ds_read_b64_tr_b16 v[46:47], v2 offset:25088
    s_mov_b64 exec, s[96:97]
    buffer_store_dwordx2 v[92:93], v26, s[72:75], s40 offen offset:1536 sc1
    s_mov_b64 exec, -1
    s_waitcnt lgkmcnt(6)
    v_mfma_f32_32x32x16_bf16 v[48:63], v[32:35], v[144:147], v[48:63]
    v_mfma_f32_16x16x32_bf16 v[20:23], v[32:35], v[16:19], v[20:23]
    ds_read_b64_tr_b16 v[32:33], v3 offset:16384
    ds_read_b64_tr_b16 v[34:35], v3 offset:16896
    s_waitcnt lgkmcnt(6)
    v_mfma_f32_32x32x16_bf16 v[64:79], v[36:39], v[144:147], v[64:79]
    ds_read_b64_tr_b16 v[36:37], v3 offset:24576
    ds_read_b64_tr_b16 v[38:39], v3 offset:25088
    s_waitcnt lgkmcnt(6)
    v_mfma_f32_32x32x16_bf16 v[48:63], v[40:43], v[148:151], v[48:63]
    ds_read_b64_tr_b16 v[40:41], v25 offset:16384
    ds_read_b64_tr_b16 v[42:43], v25 offset:16896
    s_waitcnt lgkmcnt(6)
    v_mfma_f32_32x32x16_bf16 v[64:79], v[44:47], v[148:151], v[64:79]
    ds_read_b64_tr_b16 v[44:45], v25 offset:24576
    ds_read_b64_tr_b16 v[46:47], v25 offset:25088
    s_waitcnt lgkmcnt(6)
    v_mfma_f32_32x32x16_bf16 v[48:63], v[32:35], v[152:155], v[48:63]
    s_waitcnt lgkmcnt(0)
    s_waitcnt vmcnt(14)
    s_barrier
    ds_read_b64_tr_b16 v[32:33], v1 offset:32768
    ds_read_b64_tr_b16 v[34:35], v1 offset:33280
    v_mfma_f32_32x32x16_bf16 v[64:79], v[36:39], v[152:155], v[64:79]
    v_mfma_f32_16x16x32_bf16 v[12:15], v[36:39], v[16:19], v[12:15]
    ds_read_b64_tr_b16 v[36:37], v1 offset:40960
    ds_read_b64_tr_b16 v[38:39], v1 offset:41472
    v_mfma_f32_32x32x16_bf16 v[48:63], v[40:43], v[156:159], v[48:63]
    ds_read_b64_tr_b16 v[40:41], v2 offset:32768
    ds_read_b64_tr_b16 v[42:43], v2 offset:33280
    v_mov_b32 v104, -1
    v_mov_b32 v105, -1
    v_mov_b32 v106, -1
    v_mfma_f32_32x32x16_bf16 v[64:79], v[44:47], v[156:159], v[64:79]
    ds_read_b64_tr_b16 v[44:45], v2 offset:40960
    ds_read_b64_tr_b16 v[46:47], v2 offset:41472
    v_mov_b32 v107, -1
    s_lshr_b32 s33, s2, 2
    s_mul_i32 s33, s33, 139264
    s_and_b32 s46, s2, 3
    s_mul_i32 s46, s46, 10240
    s_add_u32 s33, s33, s46
    s_add_u32 s33, s33, 98304
    s_add_u32 s46, s33, s30
    v_lshl_add_u32 v108, v0, 4, s46
    s_lshr_b32 s46, s30, 2
    s_add_u32 s33, s33, s46
    s_add_u32 s33, s33, 8192
    v_lshl_add_u32 v109, v0, 2, s33
    buffer_store_dwordx4 v[104:107], v108, s[76:79], 0 offen sc1
    s_waitcnt lgkmcnt(6)
    v_mfma_f32_32x32x16_bf16 v[48:63], v[32:35], v[160:163], v[48:63]
    v_mfma_f32_16x16x32_bf16 v[20:23], v[32:35], v[16:19], v[20:23]
    ds_read_b64_tr_b16 v[32:33], v3 offset:32768
    ds_read_b64_tr_b16 v[34:35], v3 offset:33280
    buffer_store_dword v104, v109, s[76:79], 0 offen sc1
    s_waitcnt lgkmcnt(6)
    v_mfma_f32_32x32x16_bf16 v[64:79], v[36:39], v[160:163], v[64:79]
    ds_read_b64_tr_b16 v[36:37], v3 offset:40960
    ds_read_b64_tr_b16 v[38:39], v3 offset:41472
    s_waitcnt lgkmcnt(6)
    v_mfma_f32_32x32x16_bf16 v[48:63], v[40:43], v[164:167], v[48:63]
    ds_read_b64_tr_b16 v[40:41], v25 offset:32768
    ds_read_b64_tr_b16 v[42:43], v25 offset:33280
    s_waitcnt lgkmcnt(6)
    v_mfma_f32_32x32x16_bf16 v[64:79], v[44:47], v[164:167], v[64:79]
    ds_read_b64_tr_b16 v[44:45], v25 offset:40960
    ds_read_b64_tr_b16 v[46:47], v25 offset:41472
    s_waitcnt lgkmcnt(6)
    v_mfma_f32_32x32x16_bf16 v[48:63], v[32:35], v[168:171], v[48:63]
    s_waitcnt lgkmcnt(0)
    s_waitcnt vmcnt(14)
    s_barrier
    ds_read_b64_tr_b16 v[32:33], v1 offset:49152
    ds_read_b64_tr_b16 v[34:35], v1 offset:49664
    v_mfma_f32_32x32x16_bf16 v[64:79], v[36:39], v[168:171], v[64:79]
    v_mfma_f32_16x16x32_bf16 v[12:15], v[36:39], v[16:19], v[12:15]
    ds_read_b64_tr_b16 v[36:37], v1 offset:57344
    ds_read_b64_tr_b16 v[38:39], v1 offset:57856
    v_mfma_f32_32x32x16_bf16 v[48:63], v[40:43], v[172:175], v[48:63]
    ds_read_b64_tr_b16 v[40:41], v2 offset:49152
    ds_read_b64_tr_b16 v[42:43], v2 offset:49664
    v_mfma_f32_32x32x16_bf16 v[64:79], v[44:47], v[172:175], v[64:79]
    ds_read_b64_tr_b16 v[44:45], v2 offset:57344
    ds_read_b64_tr_b16 v[46:47], v2 offset:57856
    s_waitcnt lgkmcnt(6)
    v_mfma_f32_32x32x16_bf16 v[48:63], v[32:35], v[176:179], v[48:63]
    v_mfma_f32_16x16x32_bf16 v[20:23], v[32:35], v[16:19], v[20:23]
    ds_read_b64_tr_b16 v[32:33], v3 offset:49152
    ds_read_b64_tr_b16 v[34:35], v3 offset:49664
    s_waitcnt lgkmcnt(6)
    v_mfma_f32_32x32x16_bf16 v[64:79], v[36:39], v[176:179], v[64:79]
    ds_read_b64_tr_b16 v[36:37], v3 offset:57344
    ds_read_b64_tr_b16 v[38:39], v3 offset:57856
    s_waitcnt lgkmcnt(6)
    v_mfma_f32_32x32x16_bf16 v[48:63], v[40:43], v[180:183], v[48:63]
    ds_read_b64_tr_b16 v[40:41], v25 offset:49152
    ds_read_b64_tr_b16 v[42:43], v25 offset:49664
    s_waitcnt lgkmcnt(6)
    v_mfma_f32_32x32x16_bf16 v[64:79], v[44:47], v[180:183], v[64:79]
    ds_read_b64_tr_b16 v[44:45], v25 offset:57344
    ds_read_b64_tr_b16 v[46:47], v25 offset:57856
    s_waitcnt lgkmcnt(6)
    v_mfma_f32_32x32x16_bf16 v[48:63], v[32:35], v[184:187], v[48:63]
    s_waitcnt lgkmcnt(0)
    s_waitcnt vmcnt(12)
    s_barrier
    v_add_u32 v1, 65536, v1
    ds_read_b64_tr_b16 v[32:33], v1 offset:0
    ds_read_b64_tr_b16 v[34:35], v1 offset:512
    v_mfma_f32_32x32x16_bf16 v[64:79], v[36:39], v[184:187], v[64:79]
    v_mfma_f32_16x16x32_bf16 v[12:15], v[36:39], v[16:19], v[12:15]
    ds_read_b64_tr_b16 v[36:37], v1 offset:8192
    ds_read_b64_tr_b16 v[38:39], v1 offset:8704
    v_mfma_f32_32x32x16_bf16 v[48:63], v[40:43], v[188:191], v[48:63]
    v_add_u32 v2, 65536, v2
    ds_read_b64_tr_b16 v[40:41], v2 offset:0
    ds_read_b64_tr_b16 v[42:43], v2 offset:512
    v_mfma_f32_32x32x16_bf16 v[64:79], v[44:47], v[188:191], v[64:79]
    ds_read_b64_tr_b16 v[44:45], v2 offset:8192
    ds_read_b64_tr_b16 v[46:47], v2 offset:8704
    s_waitcnt lgkmcnt(6)
    v_mfma_f32_32x32x16_bf16 v[48:63], v[32:35], v[192:195], v[48:63]
    v_mfma_f32_16x16x32_bf16 v[20:23], v[32:35], v[16:19], v[20:23]
    v_add_u32 v3, 65536, v3
    ds_read_b64_tr_b16 v[32:33], v3 offset:0
    ds_read_b64_tr_b16 v[34:35], v3 offset:512
    s_waitcnt lgkmcnt(6)
    v_mfma_f32_32x32x16_bf16 v[64:79], v[36:39], v[192:195], v[64:79]
    ds_read_b64_tr_b16 v[36:37], v3 offset:8192
    ds_read_b64_tr_b16 v[38:39], v3 offset:8704
    s_waitcnt lgkmcnt(6)
    v_mfma_f32_32x32x16_bf16 v[48:63], v[40:43], v[196:199], v[48:63]
    v_add_u32 v25, 65536, v25
    ds_read_b64_tr_b16 v[40:41], v25 offset:0
    ds_read_b64_tr_b16 v[42:43], v25 offset:512
    s_waitcnt lgkmcnt(6)
    v_mfma_f32_32x32x16_bf16 v[64:79], v[44:47], v[196:199], v[64:79]
    ds_read_b64_tr_b16 v[44:45], v25 offset:8192
    ds_read_b64_tr_b16 v[46:47], v25 offset:8704
    s_waitcnt lgkmcnt(6)
    v_mfma_f32_32x32x16_bf16 v[48:63], v[32:35], v[200:203], v[48:63]
    s_waitcnt lgkmcnt(0)
    s_waitcnt vmcnt(10)
    s_barrier
    ds_read_b64_tr_b16 v[32:33], v1 offset:16384
    ds_read_b64_tr_b16 v[34:35], v1 offset:16896
    v_mfma_f32_32x32x16_bf16 v[64:79], v[36:39], v[200:203], v[64:79]
    v_mfma_f32_16x16x32_bf16 v[12:15], v[36:39], v[16:19], v[12:15]
    ds_read_b64_tr_b16 v[36:37], v1 offset:24576
    ds_read_b64_tr_b16 v[38:39], v1 offset:25088
    v_mfma_f32_32x32x16_bf16 v[48:63], v[40:43], v[204:207], v[48:63]
    ds_read_b64_tr_b16 v[40:41], v2 offset:16384
    ds_read_b64_tr_b16 v[42:43], v2 offset:16896
    v_mfma_f32_32x32x16_bf16 v[64:79], v[44:47], v[204:207], v[64:79]
    ds_read_b64_tr_b16 v[44:45], v2 offset:24576
    ds_read_b64_tr_b16 v[46:47], v2 offset:25088
    s_waitcnt lgkmcnt(6)
    v_mfma_f32_32x32x16_bf16 v[48:63], v[32:35], v[208:211], v[48:63]
    v_mfma_f32_16x16x32_bf16 v[20:23], v[32:35], v[16:19], v[20:23]
    ds_read_b64_tr_b16 v[32:33], v3 offset:16384
    ds_read_b64_tr_b16 v[34:35], v3 offset:16896
    s_waitcnt lgkmcnt(6)
    v_mfma_f32_32x32x16_bf16 v[64:79], v[36:39], v[208:211], v[64:79]
    ds_read_b64_tr_b16 v[36:37], v3 offset:24576
    ds_read_b64_tr_b16 v[38:39], v3 offset:25088
    s_waitcnt lgkmcnt(6)
    v_mfma_f32_32x32x16_bf16 v[48:63], v[40:43], v[212:215], v[48:63]
    ds_read_b64_tr_b16 v[40:41], v25 offset:16384
    ds_read_b64_tr_b16 v[42:43], v25 offset:16896
    s_waitcnt lgkmcnt(6)
    v_mfma_f32_32x32x16_bf16 v[64:79], v[44:47], v[212:215], v[64:79]
    ds_read_b64_tr_b16 v[44:45], v25 offset:24576
    ds_read_b64_tr_b16 v[46:47], v25 offset:25088
    s_waitcnt lgkmcnt(6)
    v_mfma_f32_32x32x16_bf16 v[48:63], v[32:35], v[216:219], v[48:63]
    s_waitcnt lgkmcnt(0)
    s_waitcnt vmcnt(8)
    s_barrier
    ds_read_b64_tr_b16 v[32:33], v1 offset:32768
    ds_read_b64_tr_b16 v[34:35], v1 offset:33280
    v_mfma_f32_32x32x16_bf16 v[64:79], v[36:39], v[216:219], v[64:79]
    v_mfma_f32_16x16x32_bf16 v[12:15], v[36:39], v[16:19], v[12:15]
    ds_read_b64_tr_b16 v[36:37], v1 offset:40960
    ds_read_b64_tr_b16 v[38:39], v1 offset:41472
    v_mfma_f32_32x32x16_bf16 v[48:63], v[40:43], v[220:223], v[48:63]
    ds_read_b64_tr_b16 v[40:41], v2 offset:32768
    ds_read_b64_tr_b16 v[42:43], v2 offset:33280
    v_mfma_f32_32x32x16_bf16 v[64:79], v[44:47], v[220:223], v[64:79]
    ds_read_b64_tr_b16 v[44:45], v2 offset:40960
    ds_read_b64_tr_b16 v[46:47], v2 offset:41472
    s_waitcnt lgkmcnt(6)
    v_mfma_f32_32x32x16_bf16 v[48:63], v[32:35], v[224:227], v[48:63]
    v_mfma_f32_16x16x32_bf16 v[20:23], v[32:35], v[16:19], v[20:23]
    ds_read_b64_tr_b16 v[32:33], v3 offset:32768
    ds_read_b64_tr_b16 v[34:35], v3 offset:33280
    s_waitcnt lgkmcnt(6)
    v_mfma_f32_32x32x16_bf16 v[64:79], v[36:39], v[224:227], v[64:79]
    ds_read_b64_tr_b16 v[36:37], v3 offset:40960
    ds_read_b64_tr_b16 v[38:39], v3 offset:41472
    s_waitcnt lgkmcnt(6)
    v_mfma_f32_32x32x16_bf16 v[48:63], v[40:43], v[228:231], v[48:63]
    ds_read_b64_tr_b16 v[40:41], v25 offset:32768
    ds_read_b64_tr_b16 v[42:43], v25 offset:33280
    s_waitcnt lgkmcnt(6)
    v_mfma_f32_32x32x16_bf16 v[64:79], v[44:47], v[228:231], v[64:79]
    ds_read_b64_tr_b16 v[44:45], v25 offset:40960
    ds_read_b64_tr_b16 v[46:47], v25 offset:41472
    s_waitcnt lgkmcnt(6)
    v_mfma_f32_32x32x16_bf16 v[48:63], v[32:35], v[232:235], v[48:63]
    s_waitcnt lgkmcnt(0)
    s_waitcnt vmcnt(6)
    s_barrier
    ds_read_b64_tr_b16 v[32:33], v1 offset:49152
    ds_read_b64_tr_b16 v[34:35], v1 offset:49664
    v_mfma_f32_32x32x16_bf16 v[64:79], v[36:39], v[232:235], v[64:79]
    v_mfma_f32_16x16x32_bf16 v[12:15], v[36:39], v[16:19], v[12:15]
    ds_read_b64_tr_b16 v[36:37], v1 offset:57344
    ds_read_b64_tr_b16 v[38:39], v1 offset:57856
    v_mfma_f32_32x32x16_bf16 v[48:63], v[40:43], v[236:239], v[48:63]
    ds_read_b64_tr_b16 v[40:41], v2 offset:49152
    ds_read_b64_tr_b16 v[42:43], v2 offset:49664
    s_cmp_ge_u32 s89, 680
    s_cbranch_scc1 K1S_4
    s_waitcnt vmcnt(0)
    ds_read_b64_tr_b16 v[112:113], v5 offset:0
    ds_read_b64_tr_b16 v[114:115], v6 offset:0
    ds_read_b64_tr_b16 v[116:117], v5 offset:32
    ds_read_b64_tr_b16 v[118:119], v6 offset:32
    ds_read_b64_tr_b16 v[120:121], v5 offset:64
    ds_read_b64_tr_b16 v[122:123], v6 offset:64
    ds_read_b64_tr_b16 v[124:125], v5 offset:96
    ds_read_b64_tr_b16 v[126:127], v6 offset:96
    s_waitcnt lgkmcnt(0)
    buffer_store_dwordx4 v[112:115], v7, s[84:87], s88 offen offset:0 sc1
    buffer_store_dwordx4 v[116:119], v7, s[84:87], s88 offen offset:1024 sc1
    buffer_store_dwordx4 v[120:123], v7, s[84:87], s88 offen offset:2048 sc1
    buffer_store_dwordx4 v[124:127], v7, s[84:87], s88 offen offset:3072 sc1
K1S_4:
    v_mfma_f32_32x32x16_bf16 v[64:79], v[44:47], v[236:239], v[64:79]
    ds_read_b64_tr_b16 v[44:45], v2 offset:57344
    ds_read_b64_tr_b16 v[46:47], v2 offset:57856
    s_waitcnt lgkmcnt(6)
    v_mfma_f32_32x32x16_bf16 v[48:63], v[32:35], v[240:243], v[48:63]
    v_mfma_f32_16x16x32_bf16 v[20:23], v[32:35], v[16:19], v[20:23]
    ds_read_b64_tr_b16 v[32:33], v3 offset:49152
    ds_read_b64_tr_b16 v[34:35], v3 offset:49664
    s_waitcnt lgkmcnt(6)
    v_mfma_f32_32x32x16_bf16 v[64:79], v[36:39], v[240:243], v[64:79]
    ds_read_b64_tr_b16 v[36:37], v3 offset:57344
    ds_read_b64_tr_b16 v[38:39], v3 offset:57856
    s_waitcnt lgkmcnt(6)
    v_mfma_f32_32x32x16_bf16 v[48:63], v[40:43], v[244:247], v[48:63]
    ds_read_b64_tr_b16 v[40:41], v25 offset:49152
    ds_read_b64_tr_b16 v[42:43], v25 offset:49664
    s_waitcnt lgkmcnt(6)
    v_mfma_f32_32x32x16_bf16 v[64:79], v[44:47], v[244:247], v[64:79]
    ds_read_b64_tr_b16 v[44:45], v25 offset:57344
    ds_read_b64_tr_b16 v[46:47], v25 offset:57856
    s_waitcnt lgkmcnt(6)
    v_mfma_f32_32x32x16_bf16 v[48:63], v[32:35], v[248:251], v[48:63]
    s_waitcnt lgkmcnt(4)
    v_mfma_f32_32x32x16_bf16 v[64:79], v[36:39], v[248:251], v[64:79]
    v_mfma_f32_16x16x32_bf16 v[12:15], v[36:39], v[16:19], v[12:15]
    s_waitcnt lgkmcnt(2)
    v_mfma_f32_32x32x16_bf16 v[48:63], v[40:43], v[252:255], v[48:63]
    v_and_b32 v30, 0x31, v0
    v_mul_u32_u24 v30, 0x104, v30
    v_and_b32 v30, 0x1c0, v30
    v_add_u32 v30, s3, v30
    s_nop 4
    ds_write_b32 v30, v20 offset:0
    ds_write_b32 v30, v21 offset:16
    ds_write_b32 v30, v22 offset:32
    ds_write_b32 v30, v23 offset:48
    ds_write_b32 v30, v12 offset:2048
    ds_write_b32 v30, v13 offset:2064
    ds_write_b32 v30, v14 offset:2080
    ds_write_b32 v30, v15 offset:2096
    s_waitcnt lgkmcnt(8)
    v_mfma_f32_32x32x16_bf16 v[64:79], v[44:47], v[252:255], v[64:79]
    s_waitcnt lgkmcnt(0)
    s_barrier
    ds_read_b128 v[96:99], v31 offset:0
    ds_read_b128 v[100:103], v31 offset:2048
    s_waitcnt lgkmcnt(1)
    v_add_f32 v96, v96, v97
    v_add_f32 v98, v98, v99
    v_add_f32 v96, v96, v98
    v_cvt_pk_bf16_f32 v98, v96, v96
    v_and_b32 v98, s93, v98
    v_sub_f32 v99, v96, v98
    v_cvt_pk_bf16_f32 v98, v96, v99
    v_cvt_pk_bf16_f32 v99, v96, v99
    s_nop 1
    v_mfma_f32_32x32x8bf16_1k v[48:63], v[98:99], v[10:11], v[48:63]
    s_waitcnt lgkmcnt(0)
    v_add_f32 v100, v100, v101
    v_add_f32 v102, v102, v103
    v_add_f32 v100, v100, v102
    v_cvt_pk_bf16_f32 v102, v100, v100
    v_and_b32 v102, s93, v102
    v_sub_f32 v103, v100, v102
    v_cvt_pk_bf16_f32 v102, v100, v103
    v_cvt_pk_bf16_f32 v103, v100, v103
    s_nop 1
    v_mfma_f32_32x32x8bf16_1k v[64:79], v[102:103], v[10:11], v[64:79]
    s_nop 7
    s_nop 7
    v_pk_mul_f32 v[48:49], v[48:49], v[64:65]
    v_pk_mul_f32 v[50:51], v[50:51], v[66:67]
    v_pk_mul_f32 v[52:53], v[52:53], v[68:69]
    v_pk_mul_f32 v[54:55], v[54:55], v[70:71]
    v_pk_mul_f32 v[48:49], v[48:49], v[28:29] op_sel:[0,0] op_sel_hi:[1,0]
    v_pk_mul_f32 v[50:51], v[50:51], v[28:29] op_sel:[0,0] op_sel_hi:[1,0]
    v_pk_mul_f32 v[52:53], v[52:53], v[28:29] op_sel:[0,0] op_sel_hi:[1,0]
    v_pk_mul_f32 v[54:55], v[54:55], v[28:29] op_sel:[0,0] op_sel_hi:[1,0]
    v_cvt_pk_bf16_f32 v48, v48, v49
    v_cvt_pk_bf16_f32 v49, v50, v51
    v_cvt_pk_bf16_f32 v50, v52, v53
    v_cvt_pk_bf16_f32 v51, v54, v55
    buffer_store_dwordx4 v[48:51], v27, s[76:79], s41 offen offset:0 sc1
    v_pk_mul_f32 v[56:57], v[56:57], v[72:73]
    v_pk_mul_f32 v[58:59], v[58:59], v[74:75]
    v_pk_mul_f32 v[60:61], v[60:61], v[76:77]
    v_pk_mul_f32 v[62:63], v[62:63], v[78:79]
    v_pk_mul_f32 v[56:57], v[56:57], v[28:29] op_sel:[0,0] op_sel_hi:[1,0]
    v_pk_mul_f32 v[58:59], v[58:59], v[28:29] op_sel:[0,0] op_sel_hi:[1,0]
    v_pk_mul_f32 v[60:61], v[60:61], v[28:29] op_sel:[0,0] op_sel_hi:[1,0]
    v_pk_mul_f32 v[62:63], v[62:63], v[28:29] op_sel:[0,0] op_sel_hi:[1,0]
    v_cvt_pk_bf16_f32 v56, v56, v57
    v_cvt_pk_bf16_f32 v57, v58, v59
    v_cvt_pk_bf16_f32 v58, v60, v61
    v_cvt_pk_bf16_f32 v59, v62, v63
    buffer_store_dwordx4 v[56:59], v27, s[76:79], s41 offen offset:1024 sc1
END_0:
    s_endpgm
.globl parallel_sum__sliding_block__glu_gated_bilinear__prompt_kernel
.p2align 8
.type parallel_sum__sliding_block__glu_gated_bilinear__prompt_kernel,@function
parallel_sum__sliding_block__glu_gated_bilinear__prompt_kernel:
    s_cmp_ge_u32 s2, 256
    s_cbranch_scc1 END_1
    s_load_dwordx2 s[18:19], s[0:1], 72
    s_load_dwordx2 s[4:5], s[0:1], 0
    s_load_dwordx2 s[20:21], s[0:1], 56
    s_getpc_b64 s[88:89]
PC_B:
    v_lshlrev_b32 v254, 7, v0
    s_sub_u32 s88, s88, PC_B-parallel_sum__sliding_block__glu_gated_bilinear__prompt_kernel
    s_subb_u32 s89, s89, 0
    s_mov_b32 s90, CODE_END-parallel_sum__sliding_block__glu_gated_bilinear__prompt_kernel
    s_mov_b32 s91, 0x20000
    buffer_load_dword v255, v254, s[88:91], 0 offen
    v_mov_b32 v1, v0
    v_lshrrev_b32 v2, 6, v0
    v_and_b32 v0, 63, v0
    v_readfirstlane_b32 s24, v2
    s_and_b32 s46, s2, 7
    s_lshr_b32 s47, s2, 3
    s_lshr_b32 s27, s46, 1
    s_lshl_b32 s27, s27, 2
    s_and_b32 s33, s47, 3
    s_add_u32 s27, s27, s33
    s_and_b32 s28, s46, 1
    s_lshl_b32 s28, s28, 3
    s_lshr_b32 s33, s47, 2
    s_add_u32 s28, s28, s33
    s_lshr_b32 s23, s28, 1
    s_and_b32 s22, s28, 1
    s_lshl_b32 s33, s27, 1
    s_add_u32 s22, s22, s33
    s_and_b32 s25, s24, 3
    s_and_b32 s28, s47, 1
    s_lshl_b32 s46, s46, 1
    s_add_u32 s28, s28, s46
    s_lshr_b32 s27, s47, 1
    v_lshrrev_b32 v2, 4, v0
    v_lshlrev_b32 v3, 1, v2
    v_and_b32 v4, 15, v0
    v_xor_b32 v3, v3, v4
    v_lshlrev_b32 v3, 4, v3
    v_lshl_add_u32 v8, v2, 8, v3
    v_xor_b32 v9, 0x80, v8
    s_lshl_b32 s29, s27, 2
    s_sub_u32 s29, s29, 8
    s_mul_i32 s30, s28, 2560
    s_cmp_lt_u32 s24, 4
    s_cbranch_scc1 P0_SK
    s_setprio 1
P0_SK:
    s_cmp_ge_u32 s24, 4
    s_cbranch_scc1 W3_DONE
    v_lshrrev_b32 v12, 4, v1
    v_mul_u32_u24 v12, 3072, v12
    v_and_b32 v13, 15, v1
    v_lshl_add_u32 v12, v13, 4, v12
    v_mov_b32 v16, 0x3f803f80
    v_mov_b32 v17, v16
    v_mov_b32 v18, v16
    v_mov_b32 v19, v16
    v_subrev_u32 v13, 192, v1
    v_mul_u32_u24 v14, 3072, v13
    v_add_u32 v20, s29, v13
    v_mov_b32 v21, 0x3f80
    v_cmp_gt_i32 vcc, 0, v20
    s_cmp_eq_u32 s24, 3
    s_cbranch_scc1 W3_INIT
    ds_write_b128 v12, v[16:19] offset:39424
    s_branch W3_DONE
W3_INIT:
    v_cndmask_b32 v20, 0, v21, vcc
    v_mov_b32 v21, 0
    s_mov_b64 exec, 0xfff
    ds_write_b64 v14, v[20:21] offset:2560
    ds_write_b32 v14, v21 offset:2624
    v_mov_b32 v14, 40960
    ds_write_b32 v14, v21 offset:40960
    s_mov_b64 exec, -1
W3_DONE:
    s_waitcnt lgkmcnt(0)
    s_barrier
    s_mov_b32 s72, s18
    s_mov_b32 s73, s19
    s_mov_b32 s74, 7864320
    s_mov_b32 s75, 0x20000
    s_cmp_lt_u32 s24, 4
    s_cselect_b32 s34, 40960, 0
    s_cselect_b32 s35, 36864, 0
    s_add_u32 s34, s34, s30
    s_add_u32 s34, s34, 40960
    s_mul_i32 s33, s25, 3072
    s_add_u32 s35, s35, s33
    s_add_i32 s36, s25, s29
    s_add_u32 m0, s35, 0
    s_add_i32 s33, s36, 0
    s_max_i32 s33, s33, 0
    s_mul_i32 s33, s33, 122880
    s_add_u32 s33, s33, s34
    buffer_load_dwordx4 v8, s[72:75], s33 offen lds
    buffer_load_dwordx4 v9, s[72:75], s33 offen offset:1024 lds
    s_mov_b32 exec_hi, 0
    buffer_load_dwordx4 v8, s[72:75], s33 offen offset:2048 lds
    s_mov_b32 exec_hi, -1
    s_add_u32 m0, s35, 12288
    s_add_i32 s33, s36, 4
    s_max_i32 s33, s33, 0
    s_mul_i32 s33, s33, 122880
    s_add_u32 s33, s33, s34
    buffer_load_dwordx4 v8, s[72:75], s33 offen lds
    buffer_load_dwordx4 v9, s[72:75], s33 offen offset:1024 lds
    s_mov_b32 exec_hi, 0
    buffer_load_dwordx4 v8, s[72:75], s33 offen offset:2048 lds
    s_mov_b32 exec_hi, -1
    s_add_u32 m0, s35, 24576
    s_add_i32 s33, s36, 8
    s_max_i32 s33, s33, 0
    s_mul_i32 s33, s33, 122880
    s_add_u32 s33, s33, s34
    buffer_load_dwordx4 v8, s[72:75], s33 offen lds
    buffer_load_dwordx4 v9, s[72:75], s33 offen offset:1024 lds
    s_mov_b32 exec_hi, 0
    buffer_load_dwordx4 v8, s[72:75], s33 offen offset:2048 lds
    s_mov_b32 exec_hi, -1
    s_add_u32 s76, s18, 8388608
    s_addc_u32 s77, s19, 0
    s_mov_b32 s78, 8912896
    s_mov_b32 s79, 0x20000
    s_mul_i32 s33, s22, 278528
    s_add_u32 s33, s33, 8388608
    s_add_u32 s80, s18, s33
    s_addc_u32 s81, s19, 0
    s_mov_b32 s82, 278528
    s_mov_b32 s83, 0x20000
    s_add_u32 s84, s18, 18874368
    s_addc_u32 s85, s19, 0
    s_mov_b32 s86, 2785280
    s_mov_b32 s87, 0x20000
    s_mul_i32 s33, s22, 81920
    s_mul_i32 s34, s23, 160
    s_add_u32 s33, s33, s34
    s_add_u32 s8, s4, s33
    s_addc_u32 s9, s5, 0
    s_mov_b32 s10, 80800
    s_mov_b32 s11, 0x20000
    s_add_u32 s12, s20, s33
    s_addc_u32 s13, s21, 0
    s_mov_b32 s14, 80800
    s_mov_b32 s15, 0x20000
    s_cmp_ge_u32 s24, 4
    s_cbranch_scc1 ATT_1001
    s_and_b32 s33, s22, 7
    s_mul_i32 s33, s33, 3
    s_lshr_b32 s33, s33, 1
    s_and_b32 s34, s23, 3
    s_mul_i32 s34, s34, 3
    s_add_u32 s33, s33, s34
    s_sub_u32 s34, s33, 12
    s_cmp_ge_u32 s33, 12
    s_cselect_b32 s35, s34, s33
    s_add_u32 s35, s22, s23
    s_and_b32 s35, s35, 1
    s_mul_i32 s35, s35, 6
    v_lshlrev_b32 v4, 4, v0
    v_add_u32 v5, 4096, v4
    v_lshrrev_b32 v2, 4, v0
    v_and_b32 v3, 15, v0
    v_lshlrev_b32 v6, 4, v3
    v_lshl_add_u32 v6, v2, 9, v6
    v_add_u32 v7, 139264, v6
    s_mul_i32 s16, s25, 40960
    s_mul_i32 s33, s23, 5120
    s_add_u32 s16, s16, s33
    s_lshl_b32 s17, s25, 11
    s_mul_i32 s38, s35, 163840
    s_add_u32 s38, s38, s16
    s_lshl_b32 s39, s35, 13
    s_add_u32 s39, s39, s17
    s_add_u32 s36, s16, 1966080
    s_add_u32 s37, s17, 98304
    s_waitcnt lgkmcnt(0)
    buffer_load_dwordx4 v[52:55], v6, s[80:83], s39 offen offset:0
    buffer_load_dwordx4 v[56:59], v6, s[80:83], s39 offen offset:256
    buffer_load_dwordx4 v[60:63], v7, s[80:83], s39 offen offset:0
    buffer_load_dwordx4 v[64:67], v7, s[80:83], s39 offen offset:256
    s_add_u32 s39, s39, 8192
    buffer_load_dwordx4 v[32:35], v4, s[84:87], s38 offen offset:0
    buffer_load_dwordx4 v[36:39], v4, s[84:87], s38 offen offset:1024
    buffer_load_dwordx4 v[40:43], v4, s[84:87], s38 offen offset:2048
    buffer_load_dwordx4 v[44:47], v4, s[84:87], s38 offen offset:3072
    buffer_load_dwordx4 v[48:51], v5, s[84:87], s38 offen offset:0
    s_add_u32 s38, s38, 163840
    s_cmp_eq_u32 s38, s36
    s_cselect_b32 s38, s16, s38
    s_cselect_b32 s39, s17, s39
    v_mov_b32 v2, 0
    s_waitcnt vmcnt(9)
    v_mov_b32 v3, 1
    s_mov_b64 exec, 1
    ds_add_u32 v2, v3 offset:8768
    s_mov_b64 exec, -1
    buffer_load_dwordx4 v[88:91], v6, s[80:83], s39 offen offset:0
    buffer_load_dwordx4 v[92:95], v6, s[80:83], s39 offen offset:256
    buffer_load_dwordx4 v[96:99], v7, s[80:83], s39 offen offset:0
    buffer_load_dwordx4 v[100:103], v7, s[80:83], s39 offen offset:256
    s_add_u32 s39, s39, 8192
    buffer_load_dwordx4 v[68:71], v4, s[84:87], s38 offen offset:0
    buffer_load_dwordx4 v[72:75], v4, s[84:87], s38 offen offset:1024
    buffer_load_dwordx4 v[76:79], v4, s[84:87], s38 offen offset:2048
    buffer_load_dwordx4 v[80:83], v4, s[84:87], s38 offen offset:3072
    buffer_load_dwordx4 v[84:87], v5, s[84:87], s38 offen offset:0
    s_add_u32 s38, s38, 163840
    s_cmp_eq_u32 s38, s36
    s_cselect_b32 s38, s16, s38
    s_cselect_b32 s39, s17, s39
    buffer_load_dwordx4 v[124:127], v6, s[80:83], s39 offen offset:0
    buffer_load_dwordx4 v[128:131], v6, s[80:83], s39 offen offset:256
    buffer_load_dwordx4 v[132:135], v7, s[80:83], s39 offen offset:0
    buffer_load_dwordx4 v[136:139], v7, s[80:83], s39 offen offset:256
    s_add_u32 s39, s39, 8192
    buffer_load_dwordx4 v[104:107], v4, s[84:87], s38 offen offset:0
    buffer_load_dwordx4 v[108:111], v4, s[84:87], s38 offen offset:1024
    buffer_load_dwordx4 v[112:115], v4, s[84:87], s38 offen offset:2048
    buffer_load_dwordx4 v[116:119], v4, s[84:87], s38 offen offset:3072
    buffer_load_dwordx4 v[120:123], v5, s[84:87], s38 offen offset:0
    s_add_u32 s38, s38, 163840
    s_cmp_eq_u32 s38, s36
    s_cselect_b32 s38, s16, s38
    s_cselect_b32 s39, s17, s39
    s_waitcnt vmcnt(22)
    v_mfma_f32_16x16x32_bf16 v[176:179], v[32:35], v[52:55], 0
    v_mfma_f32_16x16x32_bf16 v[180:183], v[32:35], v[56:59], 0
    buffer_load_dwordx4 v[160:163], v6, s[80:83], s39 offen offset:0
    v_mfma_f32_16x16x32_bf16 v[184:187], v[32:35], v[60:63], 0
    v_mfma_f32_16x16x32_bf16 v[188:191], v[32:35], v[64:67], 0
    buffer_load_dwordx4 v[164:167], v6, s[80:83], s39 offen offset:256
    s_waitcnt vmcnt(23)
    v_mfma_f32_16x16x32_bf16 v[192:195], v[36:39], v[52:55], 0
    v_mfma_f32_16x16x32_bf16 v[196:199], v[36:39], v[56:59], 0
    buffer_load_dwordx4 v[168:171], v7, s[80:83], s39 offen offset:0
    v_mfma_f32_16x16x32_bf16 v[200:203], v[36:39], v[60:63], 0
    v_mfma_f32_16x16x32_bf16 v[204:207], v[36:39], v[64:67], 0
    buffer_load_dwordx4 v[172:175], v7, s[80:83], s39 offen offset:256
    s_add_u32 s39, s39, 8192
    s_waitcnt vmcnt(24)
    v_mfma_f32_16x16x32_bf16 v[208:211], v[40:43], v[52:55], 0
    v_mfma_f32_16x16x32_bf16 v[212:215], v[40:43], v[56:59], 0
    buffer_load_dwordx4 v[140:143], v4, s[84:87], s38 offen offset:0
    v_mfma_f32_16x16x32_bf16 v[216:219], v[40:43], v[60:63], 0
    v_mfma_f32_16x16x32_bf16 v[220:223], v[40:43], v[64:67], 0
    buffer_load_dwordx4 v[144:147], v4, s[84:87], s38 offen offset:1024
    s_waitcnt vmcnt(25)
    v_mfma_f32_16x16x32_bf16 v[224:227], v[44:47], v[52:55], 0
    v_mfma_f32_16x16x32_bf16 v[228:231], v[44:47], v[56:59], 0
    buffer_load_dwordx4 v[148:151], v4, s[84:87], s38 offen offset:2048
    v_mfma_f32_16x16x32_bf16 v[232:235], v[44:47], v[60:63], 0
    v_mfma_f32_16x16x32_bf16 v[236:239], v[44:47], v[64:67], 0
    buffer_load_dwordx4 v[152:155], v4, s[84:87], s38 offen offset:3072
    s_waitcnt vmcnt(26)
    v_mfma_f32_16x16x32_bf16 v[240:243], v[48:51], v[52:55], 0
    v_mfma_f32_16x16x32_bf16 v[244:247], v[48:51], v[56:59], 0
    buffer_load_dwordx4 v[156:159], v5, s[84:87], s38 offen offset:0
    s_add_u32 s38, s38, 163840
    v_mfma_f32_16x16x32_bf16 v[248:251], v[48:51], v[60:63], 0
    v_mfma_f32_16x16x32_bf16 v[252:255], v[48:51], v[64:67], 0
    s_cmp_eq_u32 s38, s36
    s_cselect_b32 s38, s16, s38
    s_cselect_b32 s39, s17, s39
    s_waitcnt vmcnt(22)
    v_mfma_f32_16x16x32_bf16 v[176:179], v[68:71], v[88:91], v[176:179]
    v_mfma_f32_16x16x32_bf16 v[180:183], v[68:71], v[92:95], v[180:183]
    buffer_load_dwordx4 v[52:55], v6, s[80:83], s39 offen offset:0
    v_mfma_f32_16x16x32_bf16 v[184:187], v[68:71], v[96:99], v[184:187]
    v_mfma_f32_16x16x32_bf16 v[188:191], v[68:71], v[100:103], v[188:191]
    buffer_load_dwordx4 v[56:59], v6, s[80:83], s39 offen offset:256
    s_waitcnt vmcnt(23)
    v_mfma_f32_16x16x32_bf16 v[192:195], v[72:75], v[88:91], v[192:195]
    v_mfma_f32_16x16x32_bf16 v[196:199], v[72:75], v[92:95], v[196:199]
    buffer_load_dwordx4 v[60:63], v7, s[80:83], s39 offen offset:0
    v_mfma_f32_16x16x32_bf16 v[200:203], v[72:75], v[96:99], v[200:203]
    v_mfma_f32_16x16x32_bf16 v[204:207], v[72:75], v[100:103], v[204:207]
    buffer_load_dwordx4 v[64:67], v7, s[80:83], s39 offen offset:256
    s_add_u32 s39, s39, 8192
    s_waitcnt vmcnt(24)
    v_mfma_f32_16x16x32_bf16 v[208:211], v[76:79], v[88:91], v[208:211]
    v_mfma_f32_16x16x32_bf16 v[212:215], v[76:79], v[92:95], v[212:215]
    buffer_load_dwordx4 v[32:35], v4, s[84:87], s38 offen offset:0
    v_mfma_f32_16x16x32_bf16 v[216:219], v[76:79], v[96:99], v[216:219]
    v_mfma_f32_16x16x32_bf16 v[220:223], v[76:79], v[100:103], v[220:223]
    buffer_load_dwordx4 v[36:39], v4, s[84:87], s38 offen offset:1024
    s_waitcnt vmcnt(25)
    v_mfma_f32_16x16x32_bf16 v[224:227], v[80:83], v[88:91], v[224:227]
    v_mfma_f32_16x16x32_bf16 v[228:231], v[80:83], v[92:95], v[228:231]
    buffer_load_dwordx4 v[40:43], v4, s[84:87], s38 offen offset:2048
    v_mfma_f32_16x16x32_bf16 v[232:235], v[80:83], v[96:99], v[232:235]
    v_mfma_f32_16x16x32_bf16 v[236:239], v[80:83], v[100:103], v[236:239]
    buffer_load_dwordx4 v[44:47], v4, s[84:87], s38 offen offset:3072
    s_waitcnt vmcnt(26)
    v_mfma_f32_16x16x32_bf16 v[240:243], v[84:87], v[88:91], v[240:243]
    v_mfma_f32_16x16x32_bf16 v[244:247], v[84:87], v[92:95], v[244:247]
    buffer_load_dwordx4 v[48:51], v5, s[84:87], s38 offen offset:0
    s_add_u32 s38, s38, 163840
    v_mfma_f32_16x16x32_bf16 v[248:251], v[84:87], v[96:99], v[248:251]
    v_mfma_f32_16x16x32_bf16 v[252:255], v[84:87], v[100:103], v[252:255]
    s_cmp_eq_u32 s38, s36
    s_cselect_b32 s38, s16, s38
    s_cselect_b32 s39, s17, s39
    s_waitcnt vmcnt(22)
    v_mfma_f32_16x16x32_bf16 v[176:179], v[104:107], v[124:127], v[176:179]
    v_mfma_f32_16x16x32_bf16 v[180:183], v[104:107], v[128:131], v[180:183]
    buffer_load_dwordx4 v[88:91], v6, s[80:83], s39 offen offset:0
    v_mfma_f32_16x16x32_bf16 v[184:187], v[104:107], v[132:135], v[184:187]
    v_mfma_f32_16x16x32_bf16 v[188:191], v[104:107], v[136:139], v[188:191]
    buffer_load_dwordx4 v[92:95], v6, s[80:83], s39 offen offset:256
    s_waitcnt vmcnt(23)
    v_mfma_f32_16x16x32_bf16 v[192:195], v[108:111], v[124:127], v[192:195]
    v_mfma_f32_16x16x32_bf16 v[196:199], v[108:111], v[128:131], v[196:199]
    buffer_load_dwordx4 v[96:99], v7, s[80:83], s39 offen offset:0
    v_mfma_f32_16x16x32_bf16 v[200:203], v[108:111], v[132:135], v[200:203]
    v_mfma_f32_16x16x32_bf16 v[204:207], v[108:111], v[136:139], v[204:207]
    buffer_load_dwordx4 v[100:103], v7, s[80:83], s39 offen offset:256
    s_add_u32 s39, s39, 8192
    s_waitcnt vmcnt(24)
    v_mfma_f32_16x16x32_bf16 v[208:211], v[112:115], v[124:127], v[208:211]
    v_mfma_f32_16x16x32_bf16 v[212:215], v[112:115], v[128:131], v[212:215]
    buffer_load_dwordx4 v[68:71], v4, s[84:87], s38 offen offset:0
    v_mfma_f32_16x16x32_bf16 v[216:219], v[112:115], v[132:135], v[216:219]
    v_mfma_f32_16x16x32_bf16 v[220:223], v[112:115], v[136:139], v[220:223]
    buffer_load_dwordx4 v[72:75], v4, s[84:87], s38 offen offset:1024
    s_waitcnt vmcnt(25)
    v_mfma_f32_16x16x32_bf16 v[224:227], v[116:119], v[124:127], v[224:227]
    v_mfma_f32_16x16x32_bf16 v[228:231], v[116:119], v[128:131], v[228:231]
    buffer_load_dwordx4 v[76:79], v4, s[84:87], s38 offen offset:2048
    v_mfma_f32_16x16x32_bf16 v[232:235], v[116:119], v[132:135], v[232:235]
    v_mfma_f32_16x16x32_bf16 v[236:239], v[116:119], v[136:139], v[236:239]
    buffer_load_dwordx4 v[80:83], v4, s[84:87], s38 offen offset:3072
    s_waitcnt vmcnt(26)
    v_mfma_f32_16x16x32_bf16 v[240:243], v[120:123], v[124:127], v[240:243]
    v_mfma_f32_16x16x32_bf16 v[244:247], v[120:123], v[128:131], v[244:247]
    buffer_load_dwordx4 v[84:87], v5, s[84:87], s38 offen offset:0
    s_add_u32 s38, s38, 163840
    v_mfma_f32_16x16x32_bf16 v[248:251], v[120:123], v[132:135], v[248:251]
    v_mfma_f32_16x16x32_bf16 v[252:255], v[120:123], v[136:139], v[252:255]
    s_cmp_eq_u32 s38, s36
    s_cselect_b32 s38, s16, s38
    s_cselect_b32 s39, s17, s39
    s_waitcnt vmcnt(22)
    v_mfma_f32_16x16x32_bf16 v[176:179], v[140:143], v[160:163], v[176:179]
    v_mfma_f32_16x16x32_bf16 v[180:183], v[140:143], v[164:167], v[180:183]
    buffer_load_dwordx4 v[124:127], v6, s[80:83], s39 offen offset:0
    v_mfma_f32_16x16x32_bf16 v[184:187], v[140:143], v[168:171], v[184:187]
    v_mfma_f32_16x16x32_bf16 v[188:191], v[140:143], v[172:175], v[188:191]
    buffer_load_dwordx4 v[128:131], v6, s[80:83], s39 offen offset:256
    s_waitcnt vmcnt(23)
    v_mfma_f32_16x16x32_bf16 v[192:195], v[144:147], v[160:163], v[192:195]
    v_mfma_f32_16x16x32_bf16 v[196:199], v[144:147], v[164:167], v[196:199]
    buffer_load_dwordx4 v[132:135], v7, s[80:83], s39 offen offset:0
    v_mfma_f32_16x16x32_bf16 v[200:203], v[144:147], v[168:171], v[200:203]
    v_mfma_f32_16x16x32_bf16 v[204:207], v[144:147], v[172:175], v[204:207]
    buffer_load_dwordx4 v[136:139], v7, s[80:83], s39 offen offset:256
    s_add_u32 s39, s39, 8192
    s_waitcnt vmcnt(24)
    v_mfma_f32_16x16x32_bf16 v[208:211], v[148:151], v[160:163], v[208:211]
    v_mfma_f32_16x16x32_bf16 v[212:215], v[148:151], v[164:167], v[212:215]
    buffer_load_dwordx4 v[104:107], v4, s[84:87], s38 offen offset:0
    v_mfma_f32_16x16x32_bf16 v[216:219], v[148:151], v[168:171], v[216:219]
    v_mfma_f32_16x16x32_bf16 v[220:223], v[148:151], v[172:175], v[220:223]
    buffer_load_dwordx4 v[108:111], v4, s[84:87], s38 offen offset:1024
    s_waitcnt vmcnt(25)
    v_mfma_f32_16x16x32_bf16 v[224:227], v[152:155], v[160:163], v[224:227]
    v_mfma_f32_16x16x32_bf16 v[228:231], v[152:155], v[164:167], v[228:231]
    buffer_load_dwordx4 v[112:115], v4, s[84:87], s38 offen offset:2048
    v_mfma_f32_16x16x32_bf16 v[232:235], v[152:155], v[168:171], v[232:235]
    v_mfma_f32_16x16x32_bf16 v[236:239], v[152:155], v[172:175], v[236:239]
    buffer_load_dwordx4 v[116:119], v4, s[84:87], s38 offen offset:3072
    s_waitcnt vmcnt(26)
    v_mfma_f32_16x16x32_bf16 v[240:243], v[156:159], v[160:163], v[240:243]
    v_mfma_f32_16x16x32_bf16 v[244:247], v[156:159], v[164:167], v[244:247]
    buffer_load_dwordx4 v[120:123], v5, s[84:87], s38 offen offset:0
    s_add_u32 s38, s38, 163840
    v_mfma_f32_16x16x32_bf16 v[248:251], v[156:159], v[168:171], v[248:251]
    v_mfma_f32_16x16x32_bf16 v[252:255], v[156:159], v[172:175], v[252:255]
    s_cmp_eq_u32 s38, s36
    s_cselect_b32 s38, s16, s38
    s_cselect_b32 s39, s17, s39
    s_waitcnt vmcnt(22)
    v_mfma_f32_16x16x32_bf16 v[176:179], v[32:35], v[52:55], v[176:179]
    v_mfma_f32_16x16x32_bf16 v[180:183], v[32:35], v[56:59], v[180:183]
    buffer_load_dwordx4 v[160:163], v6, s[80:83], s39 offen offset:0
    v_mfma_f32_16x16x32_bf16 v[184:187], v[32:35], v[60:63], v[184:187]
    v_mfma_f32_16x16x32_bf16 v[188:191], v[32:35], v[64:67], v[188:191]
    buffer_load_dwordx4 v[164:167], v6, s[80:83], s39 offen offset:256
    s_waitcnt vmcnt(23)
    v_mfma_f32_16x16x32_bf16 v[192:195], v[36:39], v[52:55], v[192:195]
    v_mfma_f32_16x16x32_bf16 v[196:199], v[36:39], v[56:59], v[196:199]
    buffer_load_dwordx4 v[168:171], v7, s[80:83], s39 offen offset:0
    v_mfma_f32_16x16x32_bf16 v[200:203], v[36:39], v[60:63], v[200:203]
    v_mfma_f32_16x16x32_bf16 v[204:207], v[36:39], v[64:67], v[204:207]
    buffer_load_dwordx4 v[172:175], v7, s[80:83], s39 offen offset:256
    s_add_u32 s39, s39, 8192
    s_waitcnt vmcnt(24)
    v_mfma_f32_16x16x32_bf16 v[208:211], v[40:43], v[52:55], v[208:211]
    v_mfma_f32_16x16x32_bf16 v[212:215], v[40:43], v[56:59], v[212:215]
    buffer_load_dwordx4 v[140:143], v4, s[84:87], s38 offen offset:0
    v_mfma_f32_16x16x32_bf16 v[216:219], v[40:43], v[60:63], v[216:219]
    v_mfma_f32_16x16x32_bf16 v[220:223], v[40:43], v[64:67], v[220:223]
    buffer_load_dwordx4 v[144:147], v4, s[84:87], s38 offen offset:1024
    s_waitcnt vmcnt(25)
    v_mfma_f32_16x16x32_bf16 v[224:227], v[44:47], v[52:55], v[224:227]
    v_mfma_f32_16x16x32_bf16 v[228:231], v[44:47], v[56:59], v[228:231]
    buffer_load_dwordx4 v[148:151], v4, s[84:87], s38 offen offset:2048
    v_mfma_f32_16x16x32_bf16 v[232:235], v[44:47], v[60:63], v[232:235]
    v_mfma_f32_16x16x32_bf16 v[236:239], v[44:47], v[64:67], v[236:239]
    buffer_load_dwordx4 v[152:155], v4, s[84:87], s38 offen offset:3072
    s_waitcnt vmcnt(26)
    v_mfma_f32_16x16x32_bf16 v[240:243], v[48:51], v[52:55], v[240:243]
    v_mfma_f32_16x16x32_bf16 v[244:247], v[48:51], v[56:59], v[244:247]
    buffer_load_dwordx4 v[156:159], v5, s[84:87], s38 offen offset:0
    s_add_u32 s38, s38, 163840
    v_mfma_f32_16x16x32_bf16 v[248:251], v[48:51], v[60:63], v[248:251]
    v_mfma_f32_16x16x32_bf16 v[252:255], v[48:51], v[64:67], v[252:255]
    s_cmp_eq_u32 s38, s36
    s_cselect_b32 s38, s16, s38
    s_cselect_b32 s39, s17, s39
    s_waitcnt vmcnt(22)
    v_mfma_f32_16x16x32_bf16 v[176:179], v[68:71], v[88:91], v[176:179]
    v_mfma_f32_16x16x32_bf16 v[180:183], v[68:71], v[92:95], v[180:183]
    buffer_load_dwordx4 v[52:55], v6, s[80:83], s39 offen offset:0
    v_mfma_f32_16x16x32_bf16 v[184:187], v[68:71], v[96:99], v[184:187]
    v_mfma_f32_16x16x32_bf16 v[188:191], v[68:71], v[100:103], v[188:191]
    buffer_load_dwordx4 v[56:59], v6, s[80:83], s39 offen offset:256
    s_waitcnt vmcnt(23)
    v_mfma_f32_16x16x32_bf16 v[192:195], v[72:75], v[88:91], v[192:195]
    v_mfma_f32_16x16x32_bf16 v[196:199], v[72:75], v[92:95], v[196:199]
    buffer_load_dwordx4 v[60:63], v7, s[80:83], s39 offen offset:0
    v_mfma_f32_16x16x32_bf16 v[200:203], v[72:75], v[96:99], v[200:203]
    v_mfma_f32_16x16x32_bf16 v[204:207], v[72:75], v[100:103], v[204:207]
    buffer_load_dwordx4 v[64:67], v7, s[80:83], s39 offen offset:256
    s_add_u32 s39, s39, 8192
    s_waitcnt vmcnt(24)
    v_mfma_f32_16x16x32_bf16 v[208:211], v[76:79], v[88:91], v[208:211]
    v_mfma_f32_16x16x32_bf16 v[212:215], v[76:79], v[92:95], v[212:215]
    buffer_load_dwordx4 v[32:35], v4, s[84:87], s38 offen offset:0
    v_mfma_f32_16x16x32_bf16 v[216:219], v[76:79], v[96:99], v[216:219]
    v_mfma_f32_16x16x32_bf16 v[220:223], v[76:79], v[100:103], v[220:223]
    buffer_load_dwordx4 v[36:39], v4, s[84:87], s38 offen offset:1024
    s_waitcnt vmcnt(25)
    v_mfma_f32_16x16x32_bf16 v[224:227], v[80:83], v[88:91], v[224:227]
    v_mfma_f32_16x16x32_bf16 v[228:231], v[80:83], v[92:95], v[228:231]
    buffer_load_dwordx4 v[40:43], v4, s[84:87], s38 offen offset:2048
    v_mfma_f32_16x16x32_bf16 v[232:235], v[80:83], v[96:99], v[232:235]
    v_mfma_f32_16x16x32_bf16 v[236:239], v[80:83], v[100:103], v[236:239]
    buffer_load_dwordx4 v[44:47], v4, s[84:87], s38 offen offset:3072
    s_waitcnt vmcnt(26)
    v_mfma_f32_16x16x32_bf16 v[240:243], v[84:87], v[88:91], v[240:243]
    v_mfma_f32_16x16x32_bf16 v[244:247], v[84:87], v[92:95], v[244:247]
    buffer_load_dwordx4 v[48:51], v5, s[84:87], s38 offen offset:0
    s_add_u32 s38, s38, 163840
    v_mfma_f32_16x16x32_bf16 v[248:251], v[84:87], v[96:99], v[248:251]
    v_mfma_f32_16x16x32_bf16 v[252:255], v[84:87], v[100:103], v[252:255]
    s_cmp_eq_u32 s38, s36
    s_cselect_b32 s38, s16, s38
    s_cselect_b32 s39, s17, s39
    s_waitcnt vmcnt(22)
    v_mfma_f32_16x16x32_bf16 v[176:179], v[104:107], v[124:127], v[176:179]
    v_mfma_f32_16x16x32_bf16 v[180:183], v[104:107], v[128:131], v[180:183]
    buffer_load_dwordx4 v[88:91], v6, s[80:83], s39 offen offset:0
    v_mfma_f32_16x16x32_bf16 v[184:187], v[104:107], v[132:135], v[184:187]
    v_mfma_f32_16x16x32_bf16 v[188:191], v[104:107], v[136:139], v[188:191]
    buffer_load_dwordx4 v[92:95], v6, s[80:83], s39 offen offset:256
    s_waitcnt vmcnt(23)
    v_mfma_f32_16x16x32_bf16 v[192:195], v[108:111], v[124:127], v[192:195]
    v_mfma_f32_16x16x32_bf16 v[196:199], v[108:111], v[128:131], v[196:199]
    buffer_load_dwordx4 v[96:99], v7, s[80:83], s39 offen offset:0
    v_mfma_f32_16x16x32_bf16 v[200:203], v[108:111], v[132:135], v[200:203]
    v_mfma_f32_16x16x32_bf16 v[204:207], v[108:111], v[136:139], v[204:207]
    buffer_load_dwordx4 v[100:103], v7, s[80:83], s39 offen offset:256
    s_add_u32 s39, s39, 8192
    s_waitcnt vmcnt(24)
    v_mfma_f32_16x16x32_bf16 v[208:211], v[112:115], v[124:127], v[208:211]
    v_mfma_f32_16x16x32_bf16 v[212:215], v[112:115], v[128:131], v[212:215]
    buffer_load_dwordx4 v[68:71], v4, s[84:87], s38 offen offset:0
    v_mfma_f32_16x16x32_bf16 v[216:219], v[112:115], v[132:135], v[216:219]
    v_mfma_f32_16x16x32_bf16 v[220:223], v[112:115], v[136:139], v[220:223]
    buffer_load_dwordx4 v[72:75], v4, s[84:87], s38 offen offset:1024
    s_waitcnt vmcnt(25)
    v_mfma_f32_16x16x32_bf16 v[224:227], v[116:119], v[124:127], v[224:227]
    v_mfma_f32_16x16x32_bf16 v[228:231], v[116:119], v[128:131], v[228:231]
    buffer_load_dwordx4 v[76:79], v4, s[84:87], s38 offen offset:2048
    v_mfma_f32_16x16x32_bf16 v[232:235], v[116:119], v[132:135], v[232:235]
    v_mfma_f32_16x16x32_bf16 v[236:239], v[116:119], v[136:139], v[236:239]
    buffer_load_dwordx4 v[80:83], v4, s[84:87], s38 offen offset:3072
    s_waitcnt vmcnt(26)
    v_mfma_f32_16x16x32_bf16 v[240:243], v[120:123], v[124:127], v[240:243]
    v_mfma_f32_16x16x32_bf16 v[244:247], v[120:123], v[128:131], v[244:247]
    buffer_load_dwordx4 v[84:87], v5, s[84:87], s38 offen offset:0
    s_add_u32 s38, s38, 163840
    v_mfma_f32_16x16x32_bf16 v[248:251], v[120:123], v[132:135], v[248:251]
    v_mfma_f32_16x16x32_bf16 v[252:255], v[120:123], v[136:139], v[252:255]
    s_cmp_eq_u32 s38, s36
    s_cselect_b32 s38, s16, s38
    s_cselect_b32 s39, s17, s39
    s_waitcnt vmcnt(22)
    v_mfma_f32_16x16x32_bf16 v[176:179], v[140:143], v[160:163], v[176:179]
    v_mfma_f32_16x16x32_bf16 v[180:183], v[140:143], v[164:167], v[180:183]
    buffer_load_dwordx4 v[124:127], v6, s[80:83], s39 offen offset:0
    v_mfma_f32_16x16x32_bf16 v[184:187], v[140:143], v[168:171], v[184:187]
    v_mfma_f32_16x16x32_bf16 v[188:191], v[140:143], v[172:175], v[188:191]
    buffer_load_dwordx4 v[128:131], v6, s[80:83], s39 offen offset:256
    s_waitcnt vmcnt(23)
    v_mfma_f32_16x16x32_bf16 v[192:195], v[144:147], v[160:163], v[192:195]
    v_mfma_f32_16x16x32_bf16 v[196:199], v[144:147], v[164:167], v[196:199]
    buffer_load_dwordx4 v[132:135], v7, s[80:83], s39 offen offset:0
    v_mfma_f32_16x16x32_bf16 v[200:203], v[144:147], v[168:171], v[200:203]
    v_mfma_f32_16x16x32_bf16 v[204:207], v[144:147], v[172:175], v[204:207]
    buffer_load_dwordx4 v[136:139], v7, s[80:83], s39 offen offset:256
    s_add_u32 s39, s39, 8192
    s_waitcnt vmcnt(24)
    v_mfma_f32_16x16x32_bf16 v[208:211], v[148:151], v[160:163], v[208:211]
    v_mfma_f32_16x16x32_bf16 v[212:215], v[148:151], v[164:167], v[212:215]
    buffer_load_dwordx4 v[104:107], v4, s[84:87], s38 offen offset:0
    v_mfma_f32_16x16x32_bf16 v[216:219], v[148:151], v[168:171], v[216:219]
    v_mfma_f32_16x16x32_bf16 v[220:223], v[148:151], v[172:175], v[220:223]
    buffer_load_dwordx4 v[108:111], v4, s[84:87], s38 offen offset:1024
    s_waitcnt vmcnt(25)
    v_mfma_f32_16x16x32_bf16 v[224:227], v[152:155], v[160:163], v[224:227]
    v_mfma_f32_16x16x32_bf16 v[228:231], v[152:155], v[164:167], v[228:231]
    buffer_load_dwordx4 v[112:115], v4, s[84:87], s38 offen offset:2048
    v_mfma_f32_16x16x32_bf16 v[232:235], v[152:155], v[168:171], v[232:235]
    v_mfma_f32_16x16x32_bf16 v[236:239], v[152:155], v[172:175], v[236:239]
    buffer_load_dwordx4 v[116:119], v4, s[84:87], s38 offen offset:3072
    s_waitcnt vmcnt(26)
    v_mfma_f32_16x16x32_bf16 v[240:243], v[156:159], v[160:163], v[240:243]
    v_mfma_f32_16x16x32_bf16 v[244:247], v[156:159], v[164:167], v[244:247]
    buffer_load_dwordx4 v[120:123], v5, s[84:87], s38 offen offset:0
    s_add_u32 s38, s38, 163840
    v_mfma_f32_16x16x32_bf16 v[248:251], v[156:159], v[168:171], v[248:251]
    v_mfma_f32_16x16x32_bf16 v[252:255], v[156:159], v[172:175], v[252:255]
    s_cmp_eq_u32 s38, s36
    s_cselect_b32 s38, s16, s38
    s_cselect_b32 s39, s17, s39
    s_waitcnt vmcnt(22)
    v_mfma_f32_16x16x32_bf16 v[176:179], v[32:35], v[52:55], v[176:179]
    v_mfma_f32_16x16x32_bf16 v[180:183], v[32:35], v[56:59], v[180:183]
    buffer_load_dwordx4 v[160:163], v6, s[80:83], s39 offen offset:0
    v_mfma_f32_16x16x32_bf16 v[184:187], v[32:35], v[60:63], v[184:187]
    v_mfma_f32_16x16x32_bf16 v[188:191], v[32:35], v[64:67], v[188:191]
    buffer_load_dwordx4 v[164:167], v6, s[80:83], s39 offen offset:256
    s_waitcnt vmcnt(23)
    v_mfma_f32_16x16x32_bf16 v[192:195], v[36:39], v[52:55], v[192:195]
    v_mfma_f32_16x16x32_bf16 v[196:199], v[36:39], v[56:59], v[196:199]
    buffer_load_dwordx4 v[168:171], v7, s[80:83], s39 offen offset:0
    v_mfma_f32_16x16x32_bf16 v[200:203], v[36:39], v[60:63], v[200:203]
    v_mfma_f32_16x16x32_bf16 v[204:207], v[36:39], v[64:67], v[204:207]
    buffer_load_dwordx4 v[172:175], v7, s[80:83], s39 offen offset:256
    s_add_u32 s39, s39, 8192
    s_waitcnt vmcnt(24)
    v_mfma_f32_16x16x32_bf16 v[208:211], v[40:43], v[52:55], v[208:211]
    v_mfma_f32_16x16x32_bf16 v[212:215], v[40:43], v[56:59], v[212:215]
    buffer_load_dwordx4 v[140:143], v4, s[84:87], s38 offen offset:0
    v_mfma_f32_16x16x32_bf16 v[216:219], v[40:43], v[60:63], v[216:219]
    v_mfma_f32_16x16x32_bf16 v[220:223], v[40:43], v[64:67], v[220:223]
    buffer_load_dwordx4 v[144:147], v4, s[84:87], s38 offen offset:1024
    s_waitcnt vmcnt(25)
    v_mfma_f32_16x16x32_bf16 v[224:227], v[44:47], v[52:55], v[224:227]
    v_mfma_f32_16x16x32_bf16 v[228:231], v[44:47], v[56:59], v[228:231]
    buffer_load_dwordx4 v[148:151], v4, s[84:87], s38 offen offset:2048
    v_mfma_f32_16x16x32_bf16 v[232:235], v[44:47], v[60:63], v[232:235]
    v_mfma_f32_16x16x32_bf16 v[236:239], v[44:47], v[64:67], v[236:239]
    buffer_load_dwordx4 v[152:155], v4, s[84:87], s38 offen offset:3072
    s_waitcnt vmcnt(26)
    v_mfma_f32_16x16x32_bf16 v[240:243], v[48:51], v[52:55], v[240:243]
    v_mfma_f32_16x16x32_bf16 v[244:247], v[48:51], v[56:59], v[244:247]
    buffer_load_dwordx4 v[156:159], v5, s[84:87], s38 offen offset:0
    s_add_u32 s38, s38, 163840
    v_mfma_f32_16x16x32_bf16 v[248:251], v[48:51], v[60:63], v[248:251]
    v_mfma_f32_16x16x32_bf16 v[252:255], v[48:51], v[64:67], v[252:255]
    s_mov_b32 s38, s36
    s_mov_b32 s39, s37
    s_waitcnt vmcnt(22)
    v_mfma_f32_16x16x32_bf16 v[176:179], v[68:71], v[88:91], v[176:179]
    v_mfma_f32_16x16x32_bf16 v[180:183], v[68:71], v[92:95], v[180:183]
    buffer_load_dwordx4 v[32:35], v4, s[84:87], s38 offen offset:0
    v_mfma_f32_16x16x32_bf16 v[184:187], v[68:71], v[96:99], v[184:187]
    v_mfma_f32_16x16x32_bf16 v[188:191], v[68:71], v[100:103], v[188:191]
    buffer_load_dwordx4 v[36:39], v4, s[84:87], s38 offen offset:1024
    s_waitcnt vmcnt(23)
    v_mfma_f32_16x16x32_bf16 v[192:195], v[72:75], v[88:91], v[192:195]
    v_mfma_f32_16x16x32_bf16 v[196:199], v[72:75], v[92:95], v[196:199]
    buffer_load_dwordx4 v[40:43], v4, s[84:87], s38 offen offset:2048
    v_mfma_f32_16x16x32_bf16 v[200:203], v[72:75], v[96:99], v[200:203]
    v_mfma_f32_16x16x32_bf16 v[204:207], v[72:75], v[100:103], v[204:207]
    buffer_load_dwordx4 v[44:47], v4, s[84:87], s38 offen offset:3072
    s_waitcnt vmcnt(24)
    v_mfma_f32_16x16x32_bf16 v[208:211], v[76:79], v[88:91], v[208:211]
    v_mfma_f32_16x16x32_bf16 v[212:215], v[76:79], v[92:95], v[212:215]
    buffer_load_dwordx4 v[48:51], v5, s[84:87], s38 offen offset:0
    s_add_u32 s38, s38, 163840
    v_mfma_f32_16x16x32_bf16 v[216:219], v[76:79], v[96:99], v[216:219]
    v_mfma_f32_16x16x32_bf16 v[220:223], v[76:79], v[100:103], v[220:223]
    s_waitcnt vmcnt(24)
    v_mfma_f32_16x16x32_bf16 v[224:227], v[80:83], v[88:91], v[224:227]
    v_mfma_f32_16x16x32_bf16 v[228:231], v[80:83], v[92:95], v[228:231]
    v_mfma_f32_16x16x32_bf16 v[232:235], v[80:83], v[96:99], v[232:235]
    v_mfma_f32_16x16x32_bf16 v[236:239], v[80:83], v[100:103], v[236:239]
    s_waitcnt vmcnt(23)
    v_mfma_f32_16x16x32_bf16 v[240:243], v[84:87], v[88:91], v[240:243]
    v_mfma_f32_16x16x32_bf16 v[244:247], v[84:87], v[92:95], v[244:247]
    v_mfma_f32_16x16x32_bf16 v[248:251], v[84:87], v[96:99], v[248:251]
    v_mfma_f32_16x16x32_bf16 v[252:255], v[84:87], v[100:103], v[252:255]
    s_waitcnt vmcnt(18)
    v_mfma_f32_16x16x32_bf16 v[176:179], v[104:107], v[124:127], v[176:179]
    v_mfma_f32_16x16x32_bf16 v[180:183], v[104:107], v[128:131], v[180:183]
    buffer_load_dwordx4 v[68:71], v4, s[84:87], s38 offen offset:0
    v_mfma_f32_16x16x32_bf16 v[184:187], v[104:107], v[132:135], v[184:187]
    v_mfma_f32_16x16x32_bf16 v[188:191], v[104:107], v[136:139], v[188:191]
    buffer_load_dwordx4 v[72:75], v4, s[84:87], s38 offen offset:1024
    s_waitcnt vmcnt(19)
    v_mfma_f32_16x16x32_bf16 v[192:195], v[108:111], v[124:127], v[192:195]
    v_mfma_f32_16x16x32_bf16 v[196:199], v[108:111], v[128:131], v[196:199]
    buffer_load_dwordx4 v[76:79], v4, s[84:87], s38 offen offset:2048
    v_mfma_f32_16x16x32_bf16 v[200:203], v[108:111], v[132:135], v[200:203]
    v_mfma_f32_16x16x32_bf16 v[204:207], v[108:111], v[136:139], v[204:207]
    buffer_load_dwordx4 v[80:83], v4, s[84:87], s38 offen offset:3072
    s_waitcnt vmcnt(20)
    v_mfma_f32_16x16x32_bf16 v[208:211], v[112:115], v[124:127], v[208:211]
    v_mfma_f32_16x16x32_bf16 v[212:215], v[112:115], v[128:131], v[212:215]
    buffer_load_dwordx4 v[84:87], v5, s[84:87], s38 offen offset:0
    s_add_u32 s38, s38, 163840
    v_mfma_f32_16x16x32_bf16 v[216:219], v[112:115], v[132:135], v[216:219]
    v_mfma_f32_16x16x32_bf16 v[220:223], v[112:115], v[136:139], v[220:223]
    s_waitcnt vmcnt(20)
    v_mfma_f32_16x16x32_bf16 v[224:227], v[116:119], v[124:127], v[224:227]
    v_mfma_f32_16x16x32_bf16 v[228:231], v[116:119], v[128:131], v[228:231]
    v_mfma_f32_16x16x32_bf16 v[232:235], v[116:119], v[132:135], v[232:235]
    v_mfma_f32_16x16x32_bf16 v[236:239], v[116:119], v[136:139], v[236:239]
    s_waitcnt vmcnt(19)
    v_mfma_f32_16x16x32_bf16 v[240:243], v[120:123], v[124:127], v[240:243]
    v_mfma_f32_16x16x32_bf16 v[244:247], v[120:123], v[128:131], v[244:247]
    v_mfma_f32_16x16x32_bf16 v[248:251], v[120:123], v[132:135], v[248:251]
    v_mfma_f32_16x16x32_bf16 v[252:255], v[120:123], v[136:139], v[252:255]
    s_waitcnt vmcnt(14)
    v_mfma_f32_16x16x32_bf16 v[176:179], v[140:143], v[160:163], v[176:179]
    v_mfma_f32_16x16x32_bf16 v[180:183], v[140:143], v[164:167], v[180:183]
    buffer_load_dwordx4 v[104:107], v4, s[84:87], s38 offen offset:0
    buffer_load_dwordx4 v[108:111], v4, s[84:87], s38 offen offset:1024
    v_mfma_f32_16x16x32_bf16 v[184:187], v[140:143], v[168:171], v[184:187]
    v_mfma_f32_16x16x32_bf16 v[188:191], v[140:143], v[172:175], v[188:191]
    buffer_load_dwordx4 v[112:115], v4, s[84:87], s38 offen offset:2048
    buffer_load_dwordx4 v[116:119], v4, s[84:87], s38 offen offset:3072
    s_waitcnt vmcnt(17)
    v_mfma_f32_16x16x32_bf16 v[192:195], v[144:147], v[160:163], v[192:195]
    v_mfma_f32_16x16x32_bf16 v[196:199], v[144:147], v[164:167], v[196:199]
    buffer_load_dwordx4 v[120:123], v5, s[84:87], s38 offen offset:0
    s_add_u32 s38, s38, 163840
    buffer_load_dwordx4 v[52:55], v6, s[80:83], s39 offen offset:0
    v_mfma_f32_16x16x32_bf16 v[200:203], v[144:147], v[168:171], v[200:203]
    v_mfma_f32_16x16x32_bf16 v[204:207], v[144:147], v[172:175], v[204:207]
    buffer_load_dwordx4 v[56:59], v6, s[80:83], s39 offen offset:256
    buffer_load_dwordx4 v[60:63], v7, s[80:83], s39 offen offset:0
    s_waitcnt vmcnt(20)
    v_mfma_f32_16x16x32_bf16 v[208:211], v[148:151], v[160:163], v[208:211]
    v_mfma_f32_16x16x32_bf16 v[212:215], v[148:151], v[164:167], v[212:215]
    buffer_load_dwordx4 v[64:67], v7, s[80:83], s39 offen offset:256
    s_add_u32 s39, s39, 8192
    buffer_load_dwordx4 v[88:91], v6, s[80:83], s39 offen offset:0
    v_mfma_f32_16x16x32_bf16 v[216:219], v[148:151], v[168:171], v[216:219]
    v_mfma_f32_16x16x32_bf16 v[220:223], v[148:151], v[172:175], v[220:223]
    buffer_load_dwordx4 v[92:95], v6, s[80:83], s39 offen offset:256
    buffer_load_dwordx4 v[96:99], v7, s[80:83], s39 offen offset:0
    s_waitcnt vmcnt(23)
    v_mfma_f32_16x16x32_bf16 v[224:227], v[152:155], v[160:163], v[224:227]
    v_mfma_f32_16x16x32_bf16 v[228:231], v[152:155], v[164:167], v[228:231]
    buffer_load_dwordx4 v[100:103], v7, s[80:83], s39 offen offset:256
    s_add_u32 s39, s39, 8192
    buffer_load_dwordx4 v[124:127], v6, s[80:83], s39 offen offset:0
    v_mfma_f32_16x16x32_bf16 v[232:235], v[152:155], v[168:171], v[232:235]
    v_mfma_f32_16x16x32_bf16 v[236:239], v[152:155], v[172:175], v[236:239]
    buffer_load_dwordx4 v[128:131], v6, s[80:83], s39 offen offset:256
    buffer_load_dwordx4 v[132:135], v7, s[80:83], s39 offen offset:0
    s_waitcnt vmcnt(26)
    v_mfma_f32_16x16x32_bf16 v[240:243], v[156:159], v[160:163], v[240:243]
    v_mfma_f32_16x16x32_bf16 v[244:247], v[156:159], v[164:167], v[244:247]
    buffer_load_dwordx4 v[136:139], v7, s[80:83], s39 offen offset:256
    s_add_u32 s39, s39, 8192
    v_mfma_f32_16x16x32_bf16 v[248:251], v[156:159], v[168:171], v[248:251]
    v_mfma_f32_16x16x32_bf16 v[252:255], v[156:159], v[172:175], v[252:255]
    s_waitcnt vmcnt(8)
    v_max3_u32 v2, v52, v56, v60
    v_max_u32 v2, v2, v64
    v_cmp_eq_u32 vcc, -1, v2
    s_nop 3
    s_cbranch_vccnz RT_12
RTB_12:
    v_mfma_f32_16x16x32_bf16 v[176:179], v[32:35], v[52:55], v[176:179]
    v_mfma_f32_16x16x32_bf16 v[180:183], v[32:35], v[56:59], v[180:183]
    buffer_load_dwordx4 v[140:143], v4, s[84:87], s38 offen offset:0
    v_mfma_f32_16x16x32_bf16 v[184:187], v[32:35], v[60:63], v[184:187]
    v_mfma_f32_16x16x32_bf16 v[188:191], v[32:35], v[64:67], v[188:191]
    buffer_load_dwordx4 v[144:147], v4, s[84:87], s38 offen offset:1024
    v_mfma_f32_16x16x32_bf16 v[192:195], v[36:39], v[52:55], v[192:195]
    v_mfma_f32_16x16x32_bf16 v[196:199], v[36:39], v[56:59], v[196:199]
    buffer_load_dwordx4 v[148:151], v4, s[84:87], s38 offen offset:2048
    v_mfma_f32_16x16x32_bf16 v[200:203], v[36:39], v[60:63], v[200:203]
    v_mfma_f32_16x16x32_bf16 v[204:207], v[36:39], v[64:67], v[204:207]
    buffer_load_dwordx4 v[152:155], v4, s[84:87], s38 offen offset:3072
    v_mfma_f32_16x16x32_bf16 v[208:211], v[40:43], v[52:55], v[208:211]
    v_mfma_f32_16x16x32_bf16 v[212:215], v[40:43], v[56:59], v[212:215]
    buffer_load_dwordx4 v[156:159], v5, s[84:87], s38 offen offset:0
    s_add_u32 s38, s38, 163840
    v_mfma_f32_16x16x32_bf16 v[216:219], v[40:43], v[60:63], v[216:219]
    v_mfma_f32_16x16x32_bf16 v[220:223], v[40:43], v[64:67], v[220:223]
    buffer_load_dwordx4 v[160:163], v6, s[80:83], s39 offen offset:0
    v_mfma_f32_16x16x32_bf16 v[224:227], v[44:47], v[52:55], v[224:227]
    v_mfma_f32_16x16x32_bf16 v[228:231], v[44:47], v[56:59], v[228:231]
    buffer_load_dwordx4 v[164:167], v6, s[80:83], s39 offen offset:256
    v_mfma_f32_16x16x32_bf16 v[232:235], v[44:47], v[60:63], v[232:235]
    v_mfma_f32_16x16x32_bf16 v[236:239], v[44:47], v[64:67], v[236:239]
    buffer_load_dwordx4 v[168:171], v7, s[80:83], s39 offen offset:0
    v_mfma_f32_16x16x32_bf16 v[240:243], v[48:51], v[52:55], v[240:243]
    v_mfma_f32_16x16x32_bf16 v[244:247], v[48:51], v[56:59], v[244:247]
    buffer_load_dwordx4 v[172:175], v7, s[80:83], s39 offen offset:256
    s_add_u32 s39, s39, 8192
    v_mfma_f32_16x16x32_bf16 v[248:251], v[48:51], v[60:63], v[248:251]
    v_mfma_f32_16x16x32_bf16 v[252:255], v[48:51], v[64:67], v[252:255]
    s_waitcnt vmcnt(13)
    v_max3_u32 v2, v88, v92, v96
    v_max_u32 v2, v2, v100
    v_cmp_eq_u32 vcc, -1, v2
    s_nop 3
    s_cbranch_vccnz RT_13
RTB_13:
    v_mfma_f32_16x16x32_bf16 v[176:179], v[68:71], v[88:91], v[176:179]
    v_mfma_f32_16x16x32_bf16 v[180:183], v[68:71], v[92:95], v[180:183]
    buffer_load_dwordx4 v[32:35], v4, s[84:87], s38 offen offset:0
    v_mfma_f32_16x16x32_bf16 v[184:187], v[68:71], v[96:99], v[184:187]
    v_mfma_f32_16x16x32_bf16 v[188:191], v[68:71], v[100:103], v[188:191]
    buffer_load_dwordx4 v[36:39], v4, s[84:87], s38 offen offset:1024
    v_mfma_f32_16x16x32_bf16 v[192:195], v[72:75], v[88:91], v[192:195]
    v_mfma_f32_16x16x32_bf16 v[196:199], v[72:75], v[92:95], v[196:199]
    buffer_load_dwordx4 v[40:43], v4, s[84:87], s38 offen offset:2048
    v_mfma_f32_16x16x32_bf16 v[200:203], v[72:75], v[96:99], v[200:203]
    v_mfma_f32_16x16x32_bf16 v[204:207], v[72:75], v[100:103], v[204:207]
    buffer_load_dwordx4 v[44:47], v4, s[84:87], s38 offen offset:3072
    v_mfma_f32_16x16x32_bf16 v[208:211], v[76:79], v[88:91], v[208:211]
    v_mfma_f32_16x16x32_bf16 v[212:215], v[76:79], v[92:95], v[212:215]
    buffer_load_dwordx4 v[48:51], v5, s[84:87], s38 offen offset:0
    s_add_u32 s38, s38, 163840
    v_mfma_f32_16x16x32_bf16 v[216:219], v[76:79], v[96:99], v[216:219]
    v_mfma_f32_16x16x32_bf16 v[220:223], v[76:79], v[100:103], v[220:223]
    buffer_load_dwordx4 v[52:55], v6, s[80:83], s39 offen offset:0
    v_mfma_f32_16x16x32_bf16 v[224:227], v[80:83], v[88:91], v[224:227]
    v_mfma_f32_16x16x32_bf16 v[228:231], v[80:83], v[92:95], v[228:231]
    buffer_load_dwordx4 v[56:59], v6, s[80:83], s39 offen offset:256
    v_mfma_f32_16x16x32_bf16 v[232:235], v[80:83], v[96:99], v[232:235]
    v_mfma_f32_16x16x32_bf16 v[236:239], v[80:83], v[100:103], v[236:239]
    buffer_load_dwordx4 v[60:63], v7, s[80:83], s39 offen offset:0
    v_mfma_f32_16x16x32_bf16 v[240:243], v[84:87], v[88:91], v[240:243]
    v_mfma_f32_16x16x32_bf16 v[244:247], v[84:87], v[92:95], v[244:247]
    buffer_load_dwordx4 v[64:67], v7, s[80:83], s39 offen offset:256
    s_add_u32 s39, s39, 8192
    v_mfma_f32_16x16x32_bf16 v[248:251], v[84:87], v[96:99], v[248:251]
    v_mfma_f32_16x16x32_bf16 v[252:255], v[84:87], v[100:103], v[252:255]
    v_add_u32 v12, 0, v1
    v_lshrrev_b32 v13, 7, v12
    v_bfe_u32 v14, v12, 5, 2
    v_and_b32 v15, 15, v12
    v_lshl_add_u32 v14, v14, 4, v15
    v_mul_u32_u24 v14, 1280, v14
    v_lshl_add_u32 v14, v13, 5, v14
    v_and_b32 v13, 16, v12
    v_add_u32 v8, v13, v14
    buffer_load_dwordx4 v[16:19], v8, s[8:11], 0 offen
    v_add_u32 v12, 512, v1
    v_lshrrev_b32 v13, 7, v12
    v_bfe_u32 v14, v12, 5, 2
    v_and_b32 v15, 15, v12
    v_lshl_add_u32 v14, v14, 4, v15
    v_mul_u32_u24 v14, 1280, v14
    v_lshl_add_u32 v14, v13, 5, v14
    v_and_b32 v13, 16, v12
    v_add_u32 v9, v13, v14
    buffer_load_dwordx4 v[20:23], v9, s[8:11], 0 offen
    v_lshrrev_b32 v12, 4, v1
    v_lshlrev_b32 v12, 9, v12
    v_lshl_add_u32 v10, v15, 4, v12
    s_mul_i32 s33, s25, 20480
    v_lshl_add_u32 v11, v0, 4, s33
    s_waitcnt vmcnt(20)
    v_max3_u32 v2, v124, v128, v132
    v_max_u32 v2, v2, v136
    v_cmp_eq_u32 vcc, -1, v2
    s_nop 3
    s_cbranch_vccnz RT_14
RTB_14:
    v_mfma_f32_16x16x32_bf16 v[176:179], v[104:107], v[124:127], v[176:179]
    v_mfma_f32_16x16x32_bf16 v[180:183], v[104:107], v[128:131], v[180:183]
    v_mfma_f32_16x16x32_bf16 v[184:187], v[104:107], v[132:135], v[184:187]
    v_mfma_f32_16x16x32_bf16 v[188:191], v[104:107], v[136:139], v[188:191]
    v_mfma_f32_16x16x32_bf16 v[192:195], v[108:111], v[124:127], v[192:195]
    v_mfma_f32_16x16x32_bf16 v[196:199], v[108:111], v[128:131], v[196:199]
    v_mfma_f32_16x16x32_bf16 v[200:203], v[108:111], v[132:135], v[200:203]
    v_mfma_f32_16x16x32_bf16 v[204:207], v[108:111], v[136:139], v[204:207]
    v_mfma_f32_16x16x32_bf16 v[208:211], v[112:115], v[124:127], v[208:211]
    v_mfma_f32_16x16x32_bf16 v[212:215], v[112:115], v[128:131], v[212:215]
    v_mfma_f32_16x16x32_bf16 v[216:219], v[112:115], v[132:135], v[216:219]
    v_mfma_f32_16x16x32_bf16 v[220:223], v[112:115], v[136:139], v[220:223]
    v_mfma_f32_16x16x32_bf16 v[224:227], v[116:119], v[124:127], v[224:227]
    v_mfma_f32_16x16x32_bf16 v[228:231], v[116:119], v[128:131], v[228:231]
    v_mfma_f32_16x16x32_bf16 v[232:235], v[116:119], v[132:135], v[232:235]
    v_mfma_f32_16x16x32_bf16 v[236:239], v[116:119], v[136:139], v[236:239]
    v_mfma_f32_16x16x32_bf16 v[240:243], v[120:123], v[124:127], v[240:243]
    v_mfma_f32_16x16x32_bf16 v[244:247], v[120:123], v[128:131], v[244:247]
    v_mfma_f32_16x16x32_bf16 v[248:251], v[120:123], v[132:135], v[248:251]
    v_mfma_f32_16x16x32_bf16 v[252:255], v[120:123], v[136:139], v[252:255]
    s_waitcnt vmcnt(11)
    v_max3_u32 v2, v160, v164, v168
    v_max_u32 v2, v2, v172
    v_cmp_eq_u32 vcc, -1, v2
    s_nop 3
    s_cbranch_vccnz RT_15
RTB_15:
    v_mfma_f32_16x16x32_bf16 v[176:179], v[140:143], v[160:163], v[176:179]
    v_mfma_f32_16x16x32_bf16 v[180:183], v[140:143], v[164:167], v[180:183]
    v_mfma_f32_16x16x32_bf16 v[184:187], v[140:143], v[168:171], v[184:187]
    v_mfma_f32_16x16x32_bf16 v[188:191], v[140:143], v[172:175], v[188:191]
    v_mfma_f32_16x16x32_bf16 v[192:195], v[144:147], v[160:163], v[192:195]
    v_mfma_f32_16x16x32_bf16 v[196:199], v[144:147], v[164:167], v[196:199]
    v_mfma_f32_16x16x32_bf16 v[200:203], v[144:147], v[168:171], v[200:203]
    v_mfma_f32_16x16x32_bf16 v[204:207], v[144:147], v[172:175], v[204:207]
    v_mfma_f32_16x16x32_bf16 v[208:211], v[148:151], v[160:163], v[208:211]
    v_mfma_f32_16x16x32_bf16 v[212:215], v[148:151], v[164:167], v[212:215]
    v_mfma_f32_16x16x32_bf16 v[216:219], v[148:151], v[168:171], v[216:219]
    v_mfma_f32_16x16x32_bf16 v[220:223], v[148:151], v[172:175], v[220:223]
    v_mfma_f32_16x16x32_bf16 v[224:227], v[152:155], v[160:163], v[224:227]
    v_mfma_f32_16x16x32_bf16 v[228:231], v[152:155], v[164:167], v[228:231]
    v_mfma_f32_16x16x32_bf16 v[232:235], v[152:155], v[168:171], v[232:235]
    v_mfma_f32_16x16x32_bf16 v[236:239], v[152:155], v[172:175], v[236:239]
    v_mfma_f32_16x16x32_bf16 v[240:243], v[156:159], v[160:163], v[240:243]
    v_mfma_f32_16x16x32_bf16 v[244:247], v[156:159], v[164:167], v[244:247]
    v_mfma_f32_16x16x32_bf16 v[248:251], v[156:159], v[168:171], v[248:251]
    v_mfma_f32_16x16x32_bf16 v[252:255], v[156:159], v[172:175], v[252:255]
    v_mov_b32 v2, 40960
    s_mov_b32 s33, 0x200000
SP_1003:
    ds_read_b32 v3, v2 offset:40960
    s_sub_u32 s33, s33, 1
    s_cbranch_scc1 SP_1003_E
    s_waitcnt lgkmcnt(0)
    v_readfirstlane_b32 s35, v3
    s_cmp_lt_u32 s35, 4
    s_cbranch_scc1 SP_1003
SP_1003_E:
    s_waitcnt lgkmcnt(0)
    s_waitcnt vmcnt(2)
    v_max3_u32 v2, v52, v56, v60
    v_max_u32 v2, v2, v64
    v_cmp_eq_u32 vcc, -1, v2
    s_nop 3
    s_cbranch_vccnz RT_16
RTB_16:
    v_mfma_f32_16x16x32_bf16 v[176:179], v[32:35], v[52:55], v[176:179]
    v_mfma_f32_16x16x32_bf16 v[180:183], v[32:35], v[56:59], v[180:183]
    v_mfma_f32_16x16x32_bf16 v[184:187], v[32:35], v[60:63], v[184:187]
    v_mfma_f32_16x16x32_bf16 v[188:191], v[32:35], v[64:67], v[188:191]
    v_mfma_f32_16x16x32_bf16 v[192:195], v[36:39], v[52:55], v[192:195]
    v_mfma_f32_16x16x32_bf16 v[196:199], v[36:39], v[56:59], v[196:199]
    v_mfma_f32_16x16x32_bf16 v[200:203], v[36:39], v[60:63], v[200:203]
    v_mfma_f32_16x16x32_bf16 v[204:207], v[36:39], v[64:67], v[204:207]
    v_mfma_f32_16x16x32_bf16 v[208:211], v[40:43], v[52:55], v[208:211]
    v_mfma_f32_16x16x32_bf16 v[212:215], v[40:43], v[56:59], v[212:215]
    ds_write_b128 v11, v[176:179] offset:0
    ds_write_b128 v11, v[180:183] offset:1024
    v_mfma_f32_16x16x32_bf16 v[216:219], v[40:43], v[60:63], v[216:219]
    ds_write_b128 v11, v[184:187] offset:2048
    ds_write_b128 v11, v[188:191] offset:3072
    v_mfma_f32_16x16x32_bf16 v[220:223], v[40:43], v[64:67], v[220:223]
    ds_write_b128 v11, v[192:195] offset:4096
    ds_write_b128 v11, v[196:199] offset:5120
    v_mfma_f32_16x16x32_bf16 v[224:227], v[44:47], v[52:55], v[224:227]
    ds_write_b128 v11, v[200:203] offset:6144
    ds_write_b128 v11, v[204:207] offset:7168
    v_mfma_f32_16x16x32_bf16 v[228:231], v[44:47], v[56:59], v[228:231]
    ds_write_b128 v11, v[208:211] offset:8192
    ds_write_b128 v11, v[212:215] offset:9216
    v_mfma_f32_16x16x32_bf16 v[232:235], v[44:47], v[60:63], v[232:235]
    ds_write_b128 v11, v[216:219] offset:10240
    ds_write_b128 v11, v[220:223] offset:11264
    v_mfma_f32_16x16x32_bf16 v[236:239], v[44:47], v[64:67], v[236:239]
    ds_write_b128 v11, v[224:227] offset:12288
    v_mfma_f32_16x16x32_bf16 v[240:243], v[48:51], v[52:55], v[240:243]
    v_mfma_f32_16x16x32_bf16 v[244:247], v[48:51], v[56:59], v[244:247]
    ds_write_b128 v11, v[228:231] offset:13312
    v_mfma_f32_16x16x32_bf16 v[248:251], v[48:51], v[60:63], v[248:251]
    v_mfma_f32_16x16x32_bf16 v[252:255], v[48:51], v[64:67], v[252:255]
    ds_write_b128 v11, v[232:235] offset:14336
    s_nop 7
    ds_write_b128 v11, v[236:239] offset:15360
    ds_write_b128 v11, v[240:243] offset:16384
    ds_write_b128 v11, v[244:247] offset:17408
    ds_write_b128 v11, v[248:251] offset:18432
    ds_write_b128 v11, v[252:255] offset:19456
    s_waitcnt vmcnt(0)
    s_branch RED_1002
RT_12:
    s_mov_b32 s33, 0x20000
RTL_12:
    s_waitcnt vmcnt(0)
    s_mov_b32 s34, 0
    v_max3_u32 v2, v52, v56, v60
    v_max_u32 v2, v2, v64
    v_cmp_eq_u32 vcc, -1, v2
    s_nop 3
    s_cbranch_vccz RTS_12_12
    s_mov_b32 s34, 1
    s_add_u32 s35, s37, 0
    buffer_load_dwordx4 v[52:55], v6, s[80:83], s35 offen offset:0 sc1
    buffer_load_dwordx4 v[56:59], v6, s[80:83], s35 offen offset:256 sc1
    buffer_load_dwordx4 v[60:63], v7, s[80:83], s35 offen offset:0 sc1
    buffer_load_dwordx4 v[64:67], v7, s[80:83], s35 offen offset:256 sc1
RTS_12_12:
    v_max3_u32 v2, v88, v92, v96
    v_max_u32 v2, v2, v100
    v_cmp_eq_u32 vcc, -1, v2
    s_nop 3
    s_cbranch_vccz RTS_12_13
    s_mov_b32 s34, 1
    s_add_u32 s35, s37, 8192
    buffer_load_dwordx4 v[88:91], v6, s[80:83], s35 offen offset:0 sc1
    buffer_load_dwordx4 v[92:95], v6, s[80:83], s35 offen offset:256 sc1
    buffer_load_dwordx4 v[96:99], v7, s[80:83], s35 offen offset:0 sc1
    buffer_load_dwordx4 v[100:103], v7, s[80:83], s35 offen offset:256 sc1
RTS_12_13:
    v_max3_u32 v2, v124, v128, v132
    v_max_u32 v2, v2, v136
    v_cmp_eq_u32 vcc, -1, v2
    s_nop 3
    s_cbranch_vccz RTS_12_14
    s_mov_b32 s34, 1
    s_add_u32 s35, s37, 16384
    buffer_load_dwordx4 v[124:127], v6, s[80:83], s35 offen offset:0 sc1
    buffer_load_dwordx4 v[128:131], v6, s[80:83], s35 offen offset:256 sc1
    buffer_load_dwordx4 v[132:135], v7, s[80:83], s35 offen offset:0 sc1
    buffer_load_dwordx4 v[136:139], v7, s[80:83], s35 offen offset:256 sc1
RTS_12_14:
    s_sub_u32 s33, s33, 1
    s_cselect_b32 s34, 0, s34
    s_cmp_lg_u32 s34, 0
    s_cbranch_scc1 RTL_12
    s_waitcnt vmcnt(0)
    s_branch RTB_12
RT_13:
    s_mov_b32 s33, 0x20000
RTL_13:
    s_waitcnt vmcnt(0)
    s_mov_b32 s34, 0
    v_max3_u32 v2, v88, v92, v96
    v_max_u32 v2, v2, v100
    v_cmp_eq_u32 vcc, -1, v2
    s_nop 3
    s_cbranch_vccz RTS_13_13
    s_mov_b32 s34, 1
    s_add_u32 s35, s37, 8192
    buffer_load_dwordx4 v[88:91], v6, s[80:83], s35 offen offset:0 sc1
    buffer_load_dwordx4 v[92:95], v6, s[80:83], s35 offen offset:256 sc1
    buffer_load_dwordx4 v[96:99], v7, s[80:83], s35 offen offset:0 sc1
    buffer_load_dwordx4 v[100:103], v7, s[80:83], s35 offen offset:256 sc1
RTS_13_13:
    v_max3_u32 v2, v124, v128, v132
    v_max_u32 v2, v2, v136
    v_cmp_eq_u32 vcc, -1, v2
    s_nop 3
    s_cbranch_vccz RTS_13_14
    s_mov_b32 s34, 1
    s_add_u32 s35, s37, 16384
    buffer_load_dwordx4 v[124:127], v6, s[80:83], s35 offen offset:0 sc1
    buffer_load_dwordx4 v[128:131], v6, s[80:83], s35 offen offset:256 sc1
    buffer_load_dwordx4 v[132:135], v7, s[80:83], s35 offen offset:0 sc1
    buffer_load_dwordx4 v[136:139], v7, s[80:83], s35 offen offset:256 sc1
RTS_13_14:
    v_max3_u32 v2, v160, v164, v168
    v_max_u32 v2, v2, v172
    v_cmp_eq_u32 vcc, -1, v2
    s_nop 3
    s_cbranch_vccz RTS_13_15
    s_mov_b32 s34, 1
    s_add_u32 s35, s37, 24576
    buffer_load_dwordx4 v[160:163], v6, s[80:83], s35 offen offset:0 sc1
    buffer_load_dwordx4 v[164:167], v6, s[80:83], s35 offen offset:256 sc1
    buffer_load_dwordx4 v[168:171], v7, s[80:83], s35 offen offset:0 sc1
    buffer_load_dwordx4 v[172:175], v7, s[80:83], s35 offen offset:256 sc1
RTS_13_15:
    s_sub_u32 s33, s33, 1
    s_cselect_b32 s34, 0, s34
    s_cmp_lg_u32 s34, 0
    s_cbranch_scc1 RTL_13
    s_waitcnt vmcnt(0)
    s_branch RTB_13
RT_14:
    s_mov_b32 s33, 0x20000
RTL_14:
    s_waitcnt vmcnt(0)
    s_mov_b32 s34, 0
    v_max3_u32 v2, v124, v128, v132
    v_max_u32 v2, v2, v136
    v_cmp_eq_u32 vcc, -1, v2
    s_nop 3
    s_cbranch_vccz RTS_14_14
    s_mov_b32 s34, 1
    s_add_u32 s35, s37, 16384
    buffer_load_dwordx4 v[124:127], v6, s[80:83], s35 offen offset:0 sc1
    buffer_load_dwordx4 v[128:131], v6, s[80:83], s35 offen offset:256 sc1
    buffer_load_dwordx4 v[132:135], v7, s[80:83], s35 offen offset:0 sc1
    buffer_load_dwordx4 v[136:139], v7, s[80:83], s35 offen offset:256 sc1
RTS_14_14:
    v_max3_u32 v2, v160, v164, v168
    v_max_u32 v2, v2, v172
    v_cmp_eq_u32 vcc, -1, v2
    s_nop 3
    s_cbranch_vccz RTS_14_15
    s_mov_b32 s34, 1
    s_add_u32 s35, s37, 24576
    buffer_load_dwordx4 v[160:163], v6, s[80:83], s35 offen offset:0 sc1
    buffer_load_dwordx4 v[164:167], v6, s[80:83], s35 offen offset:256 sc1
    buffer_load_dwordx4 v[168:171], v7, s[80:83], s35 offen offset:0 sc1
    buffer_load_dwordx4 v[172:175], v7, s[80:83], s35 offen offset:256 sc1
RTS_14_15:
    v_max3_u32 v2, v52, v56, v60
    v_max_u32 v2, v2, v64
    v_cmp_eq_u32 vcc, -1, v2
    s_nop 3
    s_cbranch_vccz RTS_14_16
    s_mov_b32 s34, 1
    s_add_u32 s35, s37, 32768
    buffer_load_dwordx4 v[52:55], v6, s[80:83], s35 offen offset:0 sc1
    buffer_load_dwordx4 v[56:59], v6, s[80:83], s35 offen offset:256 sc1
    buffer_load_dwordx4 v[60:63], v7, s[80:83], s35 offen offset:0 sc1
    buffer_load_dwordx4 v[64:67], v7, s[80:83], s35 offen offset:256 sc1
RTS_14_16:
    s_sub_u32 s33, s33, 1
    s_cselect_b32 s34, 0, s34
    s_cmp_lg_u32 s34, 0
    s_cbranch_scc1 RTL_14
    s_waitcnt vmcnt(0)
    s_branch RTB_14
RT_15:
    s_mov_b32 s33, 0x20000
RTL_15:
    s_waitcnt vmcnt(0)
    s_mov_b32 s34, 0
    v_max3_u32 v2, v160, v164, v168
    v_max_u32 v2, v2, v172
    v_cmp_eq_u32 vcc, -1, v2
    s_nop 3
    s_cbranch_vccz RTS_15_15
    s_mov_b32 s34, 1
    s_add_u32 s35, s37, 24576
    buffer_load_dwordx4 v[160:163], v6, s[80:83], s35 offen offset:0 sc1
    buffer_load_dwordx4 v[164:167], v6, s[80:83], s35 offen offset:256 sc1
    buffer_load_dwordx4 v[168:171], v7, s[80:83], s35 offen offset:0 sc1
    buffer_load_dwordx4 v[172:175], v7, s[80:83], s35 offen offset:256 sc1
RTS_15_15:
    v_max3_u32 v2, v52, v56, v60
    v_max_u32 v2, v2, v64
    v_cmp_eq_u32 vcc, -1, v2
    s_nop 3
    s_cbranch_vccz RTS_15_16
    s_mov_b32 s34, 1
    s_add_u32 s35, s37, 32768
    buffer_load_dwordx4 v[52:55], v6, s[80:83], s35 offen offset:0 sc1
    buffer_load_dwordx4 v[56:59], v6, s[80:83], s35 offen offset:256 sc1
    buffer_load_dwordx4 v[60:63], v7, s[80:83], s35 offen offset:0 sc1
    buffer_load_dwordx4 v[64:67], v7, s[80:83], s35 offen offset:256 sc1
RTS_15_16:
    s_sub_u32 s33, s33, 1
    s_cselect_b32 s34, 0, s34
    s_cmp_lg_u32 s34, 0
    s_cbranch_scc1 RTL_15
    s_waitcnt vmcnt(0)
    s_branch RTB_15
RT_16:
    s_mov_b32 s33, 0x20000
RTL_16:
    s_waitcnt vmcnt(0)
    s_mov_b32 s34, 0
    v_max3_u32 v2, v52, v56, v60
    v_max_u32 v2, v2, v64
    v_cmp_eq_u32 vcc, -1, v2
    s_nop 3
    s_cbranch_vccz RTS_16_16
    s_mov_b32 s34, 1
    s_add_u32 s35, s37, 32768
    buffer_load_dwordx4 v[52:55], v6, s[80:83], s35 offen offset:0 sc1
    buffer_load_dwordx4 v[56:59], v6, s[80:83], s35 offen offset:256 sc1
    buffer_load_dwordx4 v[60:63], v7, s[80:83], s35 offen offset:0 sc1
    buffer_load_dwordx4 v[64:67], v7, s[80:83], s35 offen offset:256 sc1
RTS_16_16:
    s_sub_u32 s33, s33, 1
    s_cselect_b32 s34, 0, s34
    s_cmp_lg_u32 s34, 0
    s_cbranch_scc1 RTL_16
    s_waitcnt vmcnt(0)
    s_branch RTB_16
ATT_1001:
    s_setprio 1
    v_lshrrev_b32 v2, 5, v0
    v_and_b32 v3, 31, v0
    s_lshl_b32 s31, s27, 2
    s_add_u32 s31, s31, s25
    s_mul_i32 s33, s31, 122880
    s_add_u32 s33, s33, s30
    v_lshlrev_b32 v4, 3, v3
    v_lshl_add_u32 v5, v2, 9, v4
    buffer_load_dwordx2 v[16:17], v5, s[72:75], s33 offen offset:0
    buffer_load_dwordx2 v[18:19], v5, s[72:75], s33 offen offset:256
    buffer_load_dwordx2 v[20:21], v4, s[72:75], s33 offen offset:1024
    buffer_load_dwordx2 v[72:73], v5, s[72:75], s33 offen offset:1280
    buffer_load_dwordx2 v[74:75], v5, s[72:75], s33 offen offset:1536
    buffer_load_dwordx2 v[76:77], v4, s[72:75], s33 offen offset:2304
    v_lshlrev_b32 v6, 2, v2
    v_sub_u32 v6, v3, v6
    v_mov_b32 v7, 0xffff
    v_mov_b32 v13, 0xffff0000
    v_cmp_le_i32 s[40:41], 0, v6
    v_cmp_le_i32 s[42:43], 1, v6
    v_cmp_le_i32 s[44:45], 2, v6
    v_cmp_le_i32 s[46:47], 3, v6
    v_cmp_le_i32 s[48:49], 8, v6
    v_cmp_le_i32 s[50:51], 9, v6
    v_cmp_le_i32 s[52:53], 10, v6
    v_cmp_le_i32 s[54:55], 11, v6
    v_cmp_le_i32 s[56:57], 16, v6
    v_cmp_le_i32 s[58:59], 17, v6
    v_cmp_le_i32 s[60:61], 18, v6
    v_cmp_le_i32 s[62:63], 19, v6
    v_cmp_le_i32 s[64:65], 24, v6
    v_cmp_le_i32 s[66:67], 25, v6
    v_cmp_le_i32 s[68:69], 26, v6
    v_cmp_le_i32 s[70:71], 27, v6
    v_cndmask_b32 v14, 0, v7, s[40:41]
    v_cndmask_b32 v15, 0, v13, s[42:43]
    v_or_b32 v64, v14, v15
    v_cndmask_b32 v14, 0, v7, s[44:45]
    v_cndmask_b32 v15, 0, v13, s[46:47]
    v_or_b32 v65, v14, v15
    v_cndmask_b32 v14, 0, v7, s[48:49]
    v_cndmask_b32 v15, 0, v13, s[50:51]
    v_or_b32 v66, v14, v15
    v_cndmask_b32 v14, 0, v7, s[52:53]
    v_cndmask_b32 v15, 0, v13, s[54:55]
    v_or_b32 v67, v14, v15
    v_cndmask_b32 v14, 0, v7, s[56:57]
    v_cndmask_b32 v15, 0, v13, s[58:59]
    v_or_b32 v68, v14, v15
    v_cndmask_b32 v14, 0, v7, s[60:61]
    v_cndmask_b32 v15, 0, v13, s[62:63]
    v_or_b32 v69, v14, v15
    v_cndmask_b32 v14, 0, v7, s[64:65]
    v_cndmask_b32 v15, 0, v13, s[66:67]
    v_or_b32 v70, v14, v15
    v_cndmask_b32 v14, 0, v7, s[68:69]
    v_cndmask_b32 v15, 0, v13, s[70:71]
    v_or_b32 v71, v14, v15
    s_mul_i32 s34, s25, 3072
    v_cmp_lt_u32 vcc, 31, v0
    v_lshrrev_b32 v6, 1, v3
    v_and_b32 v7, 1, v3
    v_lshlrev_b32 v7, 3, v7
    v_add_u32 v7, s34, v7
    v_lshl_add_u32 v13, v2, 1, 0
    v_and_b32 v14, 7, v13
    v_lshlrev_b32 v14, 1, v14
    v_xor_b32 v14, v14, v6
    v_lshl_add_u32 v14, v14, 4, v7
    v_lshl_add_u32 v10, v13, 8, v14
    v_add_u32 v13, 1, v13
    v_and_b32 v14, 7, v13
    v_lshlrev_b32 v14, 1, v14
    v_xor_b32 v14, v14, v6
    v_lshl_add_u32 v14, v14, 4, v7
    v_lshl_add_u32 v11, v13, 8, v14
    v_mov_b32 v13, 4
    v_and_b32 v14, 7, v13
    v_lshlrev_b32 v14, 1, v14
    v_xor_b32 v14, v14, v6
    v_lshl_add_u32 v14, v14, 4, v7
    v_lshl_add_u32 v12, v13, 8, v14
    s_add_u32 s35, s34, 2560
    v_mov_b32 v13, s35
    v_cndmask_b32 v12, v12, v13, vcc
    v_mov_b32 v38, 0
    v_mov_b32 v39, 0
    v_mov_b32 v46, 0
    v_mov_b32 v47, 0
    v_mov_b32 v54, 0
    v_mov_b32 v55, 0
    v_mov_b32 v22, 0
    v_mov_b32 v23, 0
    v_mov_b32 v78, 0
    v_mov_b32 v79, 0
    v_mov_b32 v6, 0xf149
    v_mov_b32 v56, 0x3f803f80
    v_mov_b32 v57, 0
    v_mov_b32 v27, 0
    v_cndmask_b32 v56, v56, v57, vcc
    s_waitcnt vmcnt(6)
    v_mov_b32 v26, 1
    s_mov_b64 exec, 1
    ds_add_u32 v22, v26 offset:5696
    s_mov_b64 exec, -1
    s_waitcnt vmcnt(0)
    v_cndmask_b32 v20, v20, v6, vcc
    v_cndmask_b32 v21, v21, v22, vcc
    v_cndmask_b32 v76, v76, v6, vcc
    v_cndmask_b32 v77, v77, v22, vcc
    s_mov_b32 s33, 0x200000
SP_1004:
    ds_read_b32 v6, v22 offset:5696
    s_sub_u32 s33, s33, 1
    s_cbranch_scc1 SP_1004_E
    s_waitcnt lgkmcnt(0)
    v_readfirstlane_b32 s35, v6
    s_cmp_lt_u32 s35, 4
    s_cbranch_scc1 SP_1004
SP_1004_E:
    s_waitcnt lgkmcnt(0)
    ds_read_b64 v[32:33], v10 offset:0
    ds_read_b64 v[34:35], v11 offset:0
    ds_read_b64 v[36:37], v12 offset:0
    ds_read_b64 v[40:41], v10 offset:24576
    ds_read_b64 v[42:43], v11 offset:24576
    ds_read_b64 v[44:45], v12 offset:24576
    ds_read_b64 v[48:49], v10 offset:3072
    ds_read_b64 v[50:51], v11 offset:3072
    ds_read_b64 v[52:53], v12 offset:3072
    s_waitcnt lgkmcnt(6)
    v_mfma_f32_32x32x16_bf16 v[96:111], v[32:35], v[16:19], 0
    v_mfma_f32_32x32x16_bf16 v[96:111], v[36:39], v[20:23], v[96:111]
    ds_read_b64 v[32:33], v10 offset:6144
    ds_read_b64 v[34:35], v11 offset:6144
    ds_read_b64 v[36:37], v12 offset:6144
    v_bfe_u32 v6, v0, 4, 1
    v_and_b32 v7, 3, v0
    v_lshl_add_u32 v6, v6, 2, v7
    v_add_u32 v7, 0, v6
    v_and_b32 v4, 7, v7
    v_lshlrev_b32 v4, 1, v4
    v_bfe_u32 v5, v0, 3, 1
    v_lshl_add_u32 v5, v2, 1, v5
    v_xor_b32 v4, v4, v5
    v_lshlrev_b32 v4, 4, v4
    v_bfe_u32 v5, v0, 2, 1
    s_waitcnt lgkmcnt(6)
    v_mfma_f32_32x32x16_bf16 v[224:239], v[40:43], v[16:19], 0
    v_mfma_f32_32x32x16_bf16 v[224:239], v[44:47], v[20:23], v[224:239]
    ds_read_b64 v[40:41], v10 offset:9216
    ds_read_b64 v[42:43], v11 offset:9216
    ds_read_b64 v[44:45], v12 offset:9216
    v_lshl_add_u32 v4, v5, 3, v4
    v_cmp_lt_u32 s[36:37], 4, v6
    v_lshlrev_b32 v7, 8, v7
    v_mov_b32 v5, 2560
    s_add_u32 s35, s34, 36864
    v_cndmask_b32 v7, v7, v5, s[36:37]
    v_add3_u32 v28, v7, v4, s35
    v_xor_b32 v29, 64, v28
    v_xor_b32 v30, 128, v28
    v_xor_b32 v31, 192, v28
    s_mul_i32 s33, s28, 2560
    s_waitcnt lgkmcnt(6)
    v_mfma_f32_32x32x16_bf16 v[112:127], v[48:51], v[16:19], 0
    v_mfma_f32_32x32x16_bf16 v[112:127], v[52:55], v[20:23], v[112:127]
    ds_read_b64 v[48:49], v10 offset:12288
    ds_read_b64 v[50:51], v11 offset:12288
    ds_read_b64 v[52:53], v12 offset:12288
    v_lshlrev_b32 v6, 4, v3
    v_lshl_add_u32 v6, v2, 9, v6
    s_mul_i32 s35, s31, 139264
    s_add_u32 s33, s33, s35
    s_add_u32 s33, s33, 98304
    v_add_u32 v15, s33, v6
    s_waitcnt lgkmcnt(6)
    v_mfma_f32_32x32x16_bf16 v[128:143], v[32:35], v[16:19], 0
    v_mfma_f32_32x32x16_bf16 v[128:143], v[36:39], v[20:23], v[128:143]
    ds_read_b64 v[32:33], v10 offset:15360
    ds_read_b64 v[34:35], v11 offset:15360
    ds_read_b64 v[36:37], v12 offset:15360
    v_cndmask_b32 v224, v96, v224, s[40:41]
    v_cndmask_b32 v225, v97, v225, s[42:43]
    v_cndmask_b32 v226, v98, v226, s[44:45]
    v_cndmask_b32 v227, v99, v227, s[46:47]
    v_cndmask_b32 v228, v100, v228, s[48:49]
    v_cndmask_b32 v229, v101, v229, s[50:51]
    v_cndmask_b32 v230, v102, v230, s[52:53]
    v_cndmask_b32 v231, v103, v231, s[54:55]
    v_cndmask_b32 v232, v104, v232, s[56:57]
    v_cndmask_b32 v233, v105, v233, s[58:59]
    v_cndmask_b32 v234, v106, v234, s[60:61]
    v_cndmask_b32 v235, v107, v235, s[62:63]
    v_cndmask_b32 v236, v108, v236, s[64:65]
    v_cndmask_b32 v237, v109, v237, s[66:67]
    v_cndmask_b32 v238, v110, v238, s[68:69]
    v_cndmask_b32 v239, v111, v239, s[70:71]
    v_max_f32 v13, v224, v225
    v_max_f32 v14, v226, v227
    v_max3_f32 v13, v228, v229, v13
    v_max3_f32 v14, v230, v231, v14
    v_max3_f32 v13, v232, v233, v13
    v_max3_f32 v14, v234, v235, v14
    v_max3_f32 v13, v236, v237, v13
    v_max3_f32 v14, v238, v239, v14
    s_waitcnt lgkmcnt(6)
    v_mfma_f32_32x32x16_bf16 v[144:159], v[40:43], v[16:19], 0
    v_mfma_f32_32x32x16_bf16 v[144:159], v[44:47], v[20:23], v[144:159]
    ds_read_b64 v[40:41], v10 offset:18432
    ds_read_b64 v[42:43], v11 offset:18432
    ds_read_b64 v[44:45], v12 offset:18432
    v_max3_f32 v13, v112, v113, v13
    v_max3_f32 v14, v114, v115, v14
    v_max3_f32 v13, v116, v117, v13
    v_max3_f32 v14, v118, v119, v14
    v_max3_f32 v13, v120, v121, v13
    v_max3_f32 v14, v122, v123, v14
    v_max3_f32 v13, v124, v125, v13
    v_max3_f32 v14, v126, v127, v14
    s_waitcnt lgkmcnt(6)
    v_mfma_f32_32x32x16_bf16 v[160:175], v[48:51], v[16:19], 0
    v_mfma_f32_32x32x16_bf16 v[160:175], v[52:55], v[20:23], v[160:175]
    ds_read_b64 v[48:49], v10 offset:21504
    ds_read_b64 v[50:51], v11 offset:21504
    ds_read_b64 v[52:53], v12 offset:21504
    v_max3_f32 v13, v128, v129, v13
    v_max3_f32 v14, v130, v131, v14
    v_max3_f32 v13, v132, v133, v13
    v_max3_f32 v14, v134, v135, v14
    v_max3_f32 v13, v136, v137, v13
    v_max3_f32 v14, v138, v139, v14
    v_max3_f32 v13, v140, v141, v13
    v_max3_f32 v14, v142, v143, v14
    s_waitcnt lgkmcnt(6)
    v_mfma_f32_32x32x16_bf16 v[176:191], v[32:35], v[16:19], 0
    v_mfma_f32_32x32x16_bf16 v[176:191], v[36:39], v[20:23], v[176:191]
    v_max3_f32 v13, v144, v145, v13
    v_max3_f32 v14, v146, v147, v14
    v_max3_f32 v13, v148, v149, v13
    v_max3_f32 v14, v150, v151, v14
    v_max3_f32 v13, v152, v153, v13
    v_max3_f32 v14, v154, v155, v14
    v_max3_f32 v13, v156, v157, v13
    v_max3_f32 v14, v158, v159, v14
    s_waitcnt lgkmcnt(3)
    v_mfma_f32_32x32x16_bf16 v[192:207], v[40:43], v[16:19], 0
    v_mfma_f32_32x32x16_bf16 v[192:207], v[44:47], v[20:23], v[192:207]
    v_max3_f32 v13, v160, v161, v13
    v_max3_f32 v14, v162, v163, v14
    v_max3_f32 v13, v164, v165, v13
    v_max3_f32 v14, v166, v167, v14
    v_max3_f32 v13, v168, v169, v13
    v_max3_f32 v14, v170, v171, v14
    v_max3_f32 v13, v172, v173, v13
    v_max3_f32 v14, v174, v175, v14
    s_waitcnt lgkmcnt(0)
    v_mfma_f32_32x32x16_bf16 v[208:223], v[48:51], v[16:19], 0
    v_mfma_f32_32x32x16_bf16 v[208:223], v[52:55], v[20:23], v[208:223]
    v_max3_f32 v13, v176, v177, v13
    v_max3_f32 v14, v178, v179, v14
    v_max3_f32 v13, v180, v181, v13
    v_max3_f32 v14, v182, v183, v14
    v_max3_f32 v13, v184, v185, v13
    v_max3_f32 v14, v186, v187, v14
    v_max3_f32 v13, v188, v189, v13
    v_max3_f32 v14, v190, v191, v14
    v_max3_f32 v13, v192, v193, v13
    v_max3_f32 v14, v194, v195, v14
    v_max3_f32 v13, v196, v197, v13
    v_max3_f32 v14, v198, v199, v14
    v_max3_f32 v13, v200, v201, v13
    v_max3_f32 v14, v202, v203, v14
    v_max3_f32 v13, v204, v205, v13
    v_max3_f32 v14, v206, v207, v14
    s_mov_b32 s33, 0x200000
SP_1005:
    ds_read_b32 v6, v22 offset:8768
    s_sub_u32 s33, s33, 1
    s_cbranch_scc1 SP_1005_E
    s_waitcnt lgkmcnt(0)
    v_readfirstlane_b32 s35, v6
    s_cmp_lt_u32 s35, 4
    s_cbranch_scc1 SP_1005
SP_1005_E:
    s_waitcnt lgkmcnt(0)
    ds_read_b64_tr_b16 v[32:33], v28 offset:3072
    ds_read_b64_tr_b16 v[34:35], v29 offset:3072
    ds_read_b64_tr_b16 v[36:37], v30 offset:3072
    ds_read_b64_tr_b16 v[38:39], v31 offset:3072
    ds_read_b64_tr_b16 v[40:41], v28 offset:6144
    ds_read_b64_tr_b16 v[42:43], v29 offset:6144
    ds_read_b64_tr_b16 v[44:45], v30 offset:6144
    ds_read_b64_tr_b16 v[46:47], v31 offset:6144
    ds_read_b64_tr_b16 v[48:49], v28 offset:9216
    ds_read_b64_tr_b16 v[50:51], v29 offset:9216
    ds_read_b64_tr_b16 v[52:53], v30 offset:9216
    ds_read_b64_tr_b16 v[54:55], v31 offset:9216
    s_nop 4
    v_max3_f32 v13, v208, v209, v13
    v_max3_f32 v14, v210, v211, v14
    v_max3_f32 v13, v212, v213, v13
    v_max3_f32 v14, v214, v215, v14
    v_max3_f32 v13, v216, v217, v13
    v_max3_f32 v14, v218, v219, v14
    v_max3_f32 v13, v220, v221, v13
    v_max3_f32 v14, v222, v223, v14
    v_max_f32 v13, v13, v14
    v_mov_b32 v14, v13
    s_nop 1
    v_permlane32_swap_b32 v13, v14
    v_max_f32 v12, v13, v14
    v_cvt_pk_bf16_f32 v13, -v12, -v12
    v_and_b32 v13, 0xffff0000, v13
    v_sub_f32 v13, -v12, v13
    v_cvt_pk_bf16_f32 v26, -v12, v13
    s_nop 1
    v_mfma_f32_32x32x8bf16_1k v[112:127], v[56:57], v[26:27], v[112:127]
    v_mfma_f32_32x32x8bf16_1k v[128:143], v[56:57], v[26:27], v[128:143]
    s_nop 7
    s_nop 3
    v_exp_f32 v112, v112
    v_exp_f32 v113, v113
    v_exp_f32 v114, v114
    v_exp_f32 v115, v115
    v_exp_f32 v116, v116
    v_exp_f32 v117, v117
    v_mfma_f32_32x32x8bf16_1k v[144:159], v[56:57], v[26:27], v[144:159]
    v_exp_f32 v118, v118
    v_exp_f32 v119, v119
    v_cvt_pk_bf16_f32 v112, v112, v113
    v_cvt_pk_bf16_f32 v113, v114, v115
    v_cvt_pk_bf16_f32 v114, v116, v117
    v_cvt_pk_bf16_f32 v115, v118, v119
    v_exp_f32 v120, v120
    v_exp_f32 v121, v121
    s_waitcnt lgkmcnt(10)
    v_mfma_f32_32x32x16_bf16 v[80:95], v[32:35], v[112:115], 0
    ds_read_b64_tr_b16 v[32:33], v28 offset:12288
    ds_read_b64_tr_b16 v[34:35], v29 offset:12288
    v_exp_f32 v122, v122
    v_exp_f32 v123, v123
    v_exp_f32 v124, v124
    v_exp_f32 v125, v125
    v_exp_f32 v126, v126
    v_exp_f32 v127, v127
    v_cvt_pk_bf16_f32 v120, v120, v121
    v_cvt_pk_bf16_f32 v121, v122, v123
    v_cvt_pk_bf16_f32 v122, v124, v125
    v_cvt_pk_bf16_f32 v123, v126, v127
    v_exp_f32 v128, v128
    v_exp_f32 v129, v129
    s_waitcnt lgkmcnt(10)
    v_mfma_f32_32x32x16_bf16 v[80:95], v[36:39], v[120:123], v[80:95]
    ds_read_b64_tr_b16 v[36:37], v30 offset:12288
    ds_read_b64_tr_b16 v[38:39], v31 offset:12288
    v_exp_f32 v130, v130
    v_exp_f32 v131, v131
    v_exp_f32 v132, v132
    v_exp_f32 v133, v133
    v_mfma_f32_32x32x8bf16_1k v[160:175], v[56:57], v[26:27], v[160:175]
    v_exp_f32 v134, v134
    v_exp_f32 v135, v135
    v_cvt_pk_bf16_f32 v128, v128, v129
    v_cvt_pk_bf16_f32 v129, v130, v131
    v_cvt_pk_bf16_f32 v130, v132, v133
    v_cvt_pk_bf16_f32 v131, v134, v135
    v_exp_f32 v136, v136
    v_exp_f32 v137, v137
    s_waitcnt lgkmcnt(10)
    v_mfma_f32_32x32x16_bf16 v[80:95], v[40:43], v[128:131], v[80:95]
    ds_read_b64_tr_b16 v[40:41], v28 offset:15360
    ds_read_b64_tr_b16 v[42:43], v29 offset:15360
    v_exp_f32 v138, v138
    v_exp_f32 v139, v139
    v_exp_f32 v140, v140
    v_exp_f32 v141, v141
    v_exp_f32 v142, v142
    v_exp_f32 v143, v143
    v_cvt_pk_bf16_f32 v136, v136, v137
    v_cvt_pk_bf16_f32 v137, v138, v139
    v_cvt_pk_bf16_f32 v138, v140, v141
    v_cvt_pk_bf16_f32 v139, v142, v143
    v_exp_f32 v144, v144
    v_exp_f32 v145, v145
    s_waitcnt lgkmcnt(10)
    v_mfma_f32_32x32x16_bf16 v[80:95], v[44:47], v[136:139], v[80:95]
    ds_read_b64_tr_b16 v[44:45], v30 offset:15360
    ds_read_b64_tr_b16 v[46:47], v31 offset:15360
    v_exp_f32 v146, v146
    v_exp_f32 v147, v147
    v_exp_f32 v148, v148
    v_exp_f32 v149, v149
    v_mfma_f32_32x32x8bf16_1k v[176:191], v[56:57], v[26:27], v[176:191]
    v_exp_f32 v150, v150
    v_exp_f32 v151, v151
    v_cvt_pk_bf16_f32 v144, v144, v145
    v_cvt_pk_bf16_f32 v145, v146, v147
    v_cvt_pk_bf16_f32 v146, v148, v149
    v_cvt_pk_bf16_f32 v147, v150, v151
    v_exp_f32 v152, v152
    v_exp_f32 v153, v153
    s_waitcnt lgkmcnt(10)
    v_mfma_f32_32x32x16_bf16 v[80:95], v[48:51], v[144:147], v[80:95]
    ds_read_b64_tr_b16 v[48:49], v28 offset:18432
    ds_read_b64_tr_b16 v[50:51], v29 offset:18432
    v_exp_f32 v154, v154
    v_exp_f32 v155, v155
    v_exp_f32 v156, v156
    v_exp_f32 v157, v157
    v_exp_f32 v158, v158
    v_exp_f32 v159, v159
    v_cvt_pk_bf16_f32 v152, v152, v153
    v_cvt_pk_bf16_f32 v153, v154, v155
    v_cvt_pk_bf16_f32 v154, v156, v157
    v_cvt_pk_bf16_f32 v155, v158, v159
    v_exp_f32 v160, v160
    v_exp_f32 v161, v161
    s_waitcnt lgkmcnt(10)
    v_mfma_f32_32x32x16_bf16 v[80:95], v[52:55], v[152:155], v[80:95]
    ds_read_b64_tr_b16 v[52:53], v30 offset:18432
    ds_read_b64_tr_b16 v[54:55], v31 offset:18432
    v_exp_f32 v162, v162
    v_exp_f32 v163, v163
    v_exp_f32 v164, v164
    v_exp_f32 v165, v165
    v_mfma_f32_32x32x8bf16_1k v[192:207], v[56:57], v[26:27], v[192:207]
    v_exp_f32 v166, v166
    v_exp_f32 v167, v167
    v_cvt_pk_bf16_f32 v160, v160, v161
    v_cvt_pk_bf16_f32 v161, v162, v163
    v_cvt_pk_bf16_f32 v162, v164, v165
    v_cvt_pk_bf16_f32 v163, v166, v167
    v_exp_f32 v168, v168
    v_exp_f32 v169, v169
    s_waitcnt lgkmcnt(10)
    v_mfma_f32_32x32x16_bf16 v[80:95], v[32:35], v[160:163], v[80:95]
    ds_read_b64_tr_b16 v[32:33], v28 offset:21504
    ds_read_b64_tr_b16 v[34:35], v29 offset:21504
    v_exp_f32 v170, v170
    v_exp_f32 v171, v171
    v_exp_f32 v172, v172
    v_exp_f32 v173, v173
    v_exp_f32 v174, v174
    v_exp_f32 v175, v175
    v_cvt_pk_bf16_f32 v168, v168, v169
    v_cvt_pk_bf16_f32 v169, v170, v171
    v_cvt_pk_bf16_f32 v170, v172, v173
    v_cvt_pk_bf16_f32 v171, v174, v175
    v_exp_f32 v176, v176
    v_exp_f32 v177, v177
    s_waitcnt lgkmcnt(10)
    v_mfma_f32_32x32x16_bf16 v[80:95], v[36:39], v[168:171], v[80:95]
    ds_read_b64_tr_b16 v[36:37], v30 offset:21504
    ds_read_b64_tr_b16 v[38:39], v31 offset:21504
    v_exp_f32 v178, v178
    v_exp_f32 v179, v179
    v_exp_f32 v180, v180
    v_exp_f32 v181, v181
    v_mfma_f32_32x32x8bf16_1k v[208:223], v[56:57], v[26:27], v[208:223]
    v_exp_f32 v182, v182
    v_exp_f32 v183, v183
    v_cvt_pk_bf16_f32 v176, v176, v177
    v_cvt_pk_bf16_f32 v177, v178, v179
    v_cvt_pk_bf16_f32 v178, v180, v181
    v_cvt_pk_bf16_f32 v179, v182, v183
    v_exp_f32 v184, v184
    v_exp_f32 v185, v185
    s_waitcnt lgkmcnt(10)
    v_mfma_f32_32x32x16_bf16 v[80:95], v[40:43], v[176:179], v[80:95]
    ds_read_b64_tr_b16 v[40:41], v28 offset:24576
    ds_read_b64_tr_b16 v[42:43], v29 offset:24576
    v_exp_f32 v186, v186
    v_exp_f32 v187, v187
    v_exp_f32 v188, v188
    v_exp_f32 v189, v189
    v_exp_f32 v190, v190
    v_exp_f32 v191, v191
    v_cvt_pk_bf16_f32 v184, v184, v185
    v_cvt_pk_bf16_f32 v185, v186, v187
    v_cvt_pk_bf16_f32 v186, v188, v189
    v_cvt_pk_bf16_f32 v187, v190, v191
    v_exp_f32 v192, v192
    v_exp_f32 v193, v193
    s_waitcnt lgkmcnt(10)
    v_mfma_f32_32x32x16_bf16 v[80:95], v[44:47], v[184:187], v[80:95]
    ds_read_b64_tr_b16 v[44:45], v30 offset:24576
    ds_read_b64_tr_b16 v[46:47], v31 offset:24576
    v_exp_f32 v194, v194
    v_exp_f32 v195, v195
    v_exp_f32 v196, v196
    v_exp_f32 v197, v197
    v_mfma_f32_32x32x8bf16_1k v[224:239], v[56:57], v[26:27], v[224:239]
    v_exp_f32 v198, v198
    v_exp_f32 v199, v199
    v_cvt_pk_bf16_f32 v192, v192, v193
    v_cvt_pk_bf16_f32 v193, v194, v195
    v_cvt_pk_bf16_f32 v194, v196, v197
    v_cvt_pk_bf16_f32 v195, v198, v199
    v_exp_f32 v200, v200
    v_exp_f32 v201, v201
    s_waitcnt lgkmcnt(10)
    v_mfma_f32_32x32x16_bf16 v[80:95], v[48:51], v[192:195], v[80:95]
    ds_read_b64_tr_b16 v[48:49], v28 offset:0
    ds_read_b64_tr_b16 v[50:51], v29 offset:0
    v_exp_f32 v202, v202
    v_exp_f32 v203, v203
    v_exp_f32 v204, v204
    v_exp_f32 v205, v205
    v_exp_f32 v206, v206
    v_exp_f32 v207, v207
    v_cvt_pk_bf16_f32 v200, v200, v201
    v_cvt_pk_bf16_f32 v201, v202, v203
    v_cvt_pk_bf16_f32 v202, v204, v205
    v_cvt_pk_bf16_f32 v203, v206, v207
    v_exp_f32 v208, v208
    v_exp_f32 v209, v209
    s_waitcnt lgkmcnt(10)
    v_mfma_f32_32x32x16_bf16 v[80:95], v[52:55], v[200:203], v[80:95]
    ds_read_b64_tr_b16 v[52:53], v30 offset:0
    ds_read_b64_tr_b16 v[54:55], v31 offset:0
    v_exp_f32 v210, v210
    v_exp_f32 v211, v211
    v_exp_f32 v212, v212
    v_exp_f32 v213, v213
    v_exp_f32 v214, v214
    v_exp_f32 v215, v215
    v_cvt_pk_bf16_f32 v208, v208, v209
    v_cvt_pk_bf16_f32 v209, v210, v211
    v_cvt_pk_bf16_f32 v210, v212, v213
    v_cvt_pk_bf16_f32 v211, v214, v215
    v_exp_f32 v216, v216
    v_exp_f32 v217, v217
    s_waitcnt lgkmcnt(10)
    v_mfma_f32_32x32x16_bf16 v[80:95], v[32:35], v[208:211], v[80:95]
    v_exp_f32 v218, v218
    v_exp_f32 v219, v219
    v_exp_f32 v220, v220
    v_exp_f32 v221, v221
    v_exp_f32 v222, v222
    v_exp_f32 v223, v223
    v_cvt_pk_bf16_f32 v216, v216, v217
    v_cvt_pk_bf16_f32 v217, v218, v219
    v_cvt_pk_bf16_f32 v218, v220, v221
    v_cvt_pk_bf16_f32 v219, v222, v223
    v_exp_f32 v224, v224
    v_exp_f32 v225, v225
    s_waitcnt lgkmcnt(8)
    v_mfma_f32_32x32x16_bf16 v[80:95], v[36:39], v[216:219], v[80:95]
    v_exp_f32 v226, v226
    v_exp_f32 v227, v227
    v_exp_f32 v228, v228
    v_exp_f32 v229, v229
    v_exp_f32 v230, v230
    v_exp_f32 v231, v231
    v_cvt_pk_bf16_f32 v224, v224, v225
    v_cvt_pk_bf16_f32 v225, v226, v227
    v_cvt_pk_bf16_f32 v226, v228, v229
    v_cvt_pk_bf16_f32 v227, v230, v231
    v_and_b32 v228, v64, v224
    v_xor_b32 v96, v228, v224
    v_mov_b32 v224, v228
    v_and_b32 v229, v65, v225
    v_xor_b32 v97, v229, v225
    v_mov_b32 v225, v229
    v_and_b32 v230, v66, v226
    v_xor_b32 v98, v230, v226
    v_mov_b32 v226, v230
    v_and_b32 v231, v67, v227
    v_xor_b32 v99, v231, v227
    v_mov_b32 v227, v231
    v_exp_f32 v232, v232
    v_exp_f32 v233, v233
    s_waitcnt lgkmcnt(6)
    v_mfma_f32_32x32x16_bf16 v[80:95], v[40:43], v[224:227], v[80:95]
    v_exp_f32 v234, v234
    v_exp_f32 v235, v235
    v_exp_f32 v236, v236
    v_exp_f32 v237, v237
    v_exp_f32 v238, v238
    v_exp_f32 v239, v239
    v_cvt_pk_bf16_f32 v232, v232, v233
    v_cvt_pk_bf16_f32 v233, v234, v235
    v_cvt_pk_bf16_f32 v234, v236, v237
    v_cvt_pk_bf16_f32 v235, v238, v239
    v_and_b32 v236, v68, v232
    v_xor_b32 v104, v236, v232
    v_mov_b32 v232, v236
    v_and_b32 v237, v69, v233
    v_xor_b32 v105, v237, v233
    v_mov_b32 v233, v237
    v_and_b32 v238, v70, v234
    v_xor_b32 v106, v238, v234
    v_mov_b32 v234, v238
    v_and_b32 v239, v71, v235
    v_xor_b32 v107, v239, v235
    v_mov_b32 v235, v239
    s_nop 1
    s_waitcnt lgkmcnt(4)
    v_mfma_f32_32x32x16_bf16 v[80:95], v[44:47], v[232:235], v[80:95]
    s_waitcnt lgkmcnt(2)
    v_mfma_f32_32x32x16_bf16 v[80:95], v[48:51], v[96:99], v[80:95]
    s_waitcnt lgkmcnt(0)
    v_mfma_f32_32x32x16_bf16 v[80:95], v[52:55], v[104:107], v[80:95]
    v_lshrrev_b32 v6, 1, v3
    v_and_b32 v7, 1, v3
    v_lshlrev_b32 v7, 3, v7
    v_add_u32 v7, s34, v7
    v_lshl_add_u32 v13, v2, 1, 5
    v_and_b32 v14, 7, v13
    v_lshlrev_b32 v14, 1, v14
    v_xor_b32 v14, v14, v6
    v_lshl_add_u32 v14, v14, 4, v7
    v_lshl_add_u32 v10, v13, 8, v14
    v_add_u32 v13, 1, v13
    v_and_b32 v14, 7, v13
    v_lshlrev_b32 v14, 1, v14
    v_xor_b32 v14, v14, v6
    v_lshl_add_u32 v14, v14, 4, v7
    v_lshl_add_u32 v11, v13, 8, v14
    v_mov_b32 v13, 9
    v_and_b32 v14, 7, v13
    v_lshlrev_b32 v14, 1, v14
    v_xor_b32 v14, v14, v6
    v_lshl_add_u32 v14, v14, 4, v7
    v_lshl_add_u32 v12, v13, 8, v14
    s_add_u32 s35, s34, 2560
    v_mov_b32 v13, s35
    v_cndmask_b32 v12, v12, v13, vcc
    v_mov_b32 v38, 0
    v_mov_b32 v39, 0
    v_mov_b32 v46, 0
    v_mov_b32 v47, 0
    v_mov_b32 v54, 0
    v_mov_b32 v55, 0
    v_rcp_f32 v14, v92
    s_nop 0
    v_mul_f32 v80, v80, v14
    v_mul_f32 v81, v81, v14
    v_mul_f32 v82, v82, v14
    v_mul_f32 v83, v83, v14
    v_cvt_pk_bf16_f32 v58, v80, v81
    v_cvt_pk_bf16_f32 v59, v82, v83
    v_mul_f32 v84, v84, v14
    v_mul_f32 v85, v85, v14
    v_mul_f32 v86, v86, v14
    v_mul_f32 v87, v87, v14
    v_cvt_pk_bf16_f32 v60, v84, v85
    v_cvt_pk_bf16_f32 v61, v86, v87
    v_mul_f32 v88, v88, v14
    v_mul_f32 v89, v89, v14
    v_mul_f32 v90, v90, v14
    v_mul_f32 v91, v91, v14
    v_cvt_pk_bf16_f32 v240, v88, v89
    v_cvt_pk_bf16_f32 v241, v90, v91
    v_permlane32_swap_b32 v58, v60
    v_permlane32_swap_b32 v59, v61
    buffer_store_dwordx4 v[58:61], v15, s[76:79], 0 offen sc1
    ds_read_b64 v[32:33], v10 offset:0
    ds_read_b64 v[34:35], v11 offset:0
    ds_read_b64 v[36:37], v12 offset:0
    ds_read_b64 v[40:41], v10 offset:24576
    ds_read_b64 v[42:43], v11 offset:24576
    ds_read_b64 v[44:45], v12 offset:24576
    ds_read_b64 v[48:49], v10 offset:3072
    ds_read_b64 v[50:51], v11 offset:3072
    ds_read_b64 v[52:53], v12 offset:3072
    s_waitcnt lgkmcnt(6)
    v_mfma_f32_32x32x16_bf16 v[96:111], v[32:35], v[72:75], 0
    v_mfma_f32_32x32x16_bf16 v[96:111], v[36:39], v[76:79], v[96:111]
    ds_read_b64 v[32:33], v10 offset:6144
    ds_read_b64 v[34:35], v11 offset:6144
    ds_read_b64 v[36:37], v12 offset:6144
    v_bfe_u32 v6, v0, 4, 1
    v_and_b32 v7, 3, v0
    v_lshl_add_u32 v6, v6, 2, v7
    v_add_u32 v7, 5, v6
    v_and_b32 v4, 7, v7
    v_lshlrev_b32 v4, 1, v4
    v_bfe_u32 v5, v0, 3, 1
    v_lshl_add_u32 v5, v2, 1, v5
    v_xor_b32 v4, v4, v5
    v_lshlrev_b32 v4, 4, v4
    v_bfe_u32 v5, v0, 2, 1
    s_waitcnt lgkmcnt(6)
    v_mfma_f32_32x32x16_bf16 v[224:239], v[40:43], v[72:75], 0
    v_mfma_f32_32x32x16_bf16 v[224:239], v[44:47], v[76:79], v[224:239]
    ds_read_b64 v[40:41], v10 offset:9216
    ds_read_b64 v[42:43], v11 offset:9216
    ds_read_b64 v[44:45], v12 offset:9216
    v_lshl_add_u32 v4, v5, 3, v4
    v_cmp_lt_u32 s[36:37], 4, v6
    v_lshlrev_b32 v7, 8, v7
    v_mov_b32 v5, 2560
    s_add_u32 s35, s34, 36864
    v_cndmask_b32 v7, v7, v5, s[36:37]
    v_add3_u32 v28, v7, v4, s35
    v_xor_b32 v29, 64, v28
    v_xor_b32 v30, 128, v28
    v_xor_b32 v31, 192, v28
    s_mul_i32 s33, s28, 2560
    s_waitcnt lgkmcnt(6)
    v_mfma_f32_32x32x16_bf16 v[112:127], v[48:51], v[72:75], 0
    v_mfma_f32_32x32x16_bf16 v[112:127], v[52:55], v[76:79], v[112:127]
    ds_read_b64 v[48:49], v10 offset:12288
    ds_read_b64 v[50:51], v11 offset:12288
    ds_read_b64 v[52:53], v12 offset:12288
    v_lshlrev_b32 v6, 4, v3
    v_lshl_add_u32 v6, v2, 9, v6
    s_mul_i32 s35, s31, 139264
    s_add_u32 s33, s33, s35
    s_add_u32 s33, s33, 98304
    v_add_u32 v15, s33, v6
    s_waitcnt lgkmcnt(6)
    v_mfma_f32_32x32x16_bf16 v[128:143], v[32:35], v[72:75], 0
    v_mfma_f32_32x32x16_bf16 v[128:143], v[36:39], v[76:79], v[128:143]
    ds_read_b64 v[32:33], v10 offset:15360
    ds_read_b64 v[34:35], v11 offset:15360
    ds_read_b64 v[36:37], v12 offset:15360
    v_cndmask_b32 v224, v96, v224, s[40:41]
    v_cndmask_b32 v225, v97, v225, s[42:43]
    v_cndmask_b32 v226, v98, v226, s[44:45]
    v_cndmask_b32 v227, v99, v227, s[46:47]
    v_cndmask_b32 v228, v100, v228, s[48:49]
    v_cndmask_b32 v229, v101, v229, s[50:51]
    v_cndmask_b32 v230, v102, v230, s[52:53]
    v_cndmask_b32 v231, v103, v231, s[54:55]
    v_cndmask_b32 v232, v104, v232, s[56:57]
    v_cndmask_b32 v233, v105, v233, s[58:59]
    v_cndmask_b32 v234, v106, v234, s[60:61]
    v_cndmask_b32 v235, v107, v235, s[62:63]
    v_cndmask_b32 v236, v108, v236, s[64:65]
    v_cndmask_b32 v237, v109, v237, s[66:67]
    v_cndmask_b32 v238, v110, v238, s[68:69]
    v_cndmask_b32 v239, v111, v239, s[70:71]
    v_max_f32 v13, v224, v225
    v_max_f32 v14, v226, v227
    v_max3_f32 v13, v228, v229, v13
    v_max3_f32 v14, v230, v231, v14
    v_max3_f32 v13, v232, v233, v13
    v_max3_f32 v14, v234, v235, v14
    v_max3_f32 v13, v236, v237, v13
    v_max3_f32 v14, v238, v239, v14
    s_waitcnt lgkmcnt(6)
    v_mfma_f32_32x32x16_bf16 v[144:159], v[40:43], v[72:75], 0
    v_mfma_f32_32x32x16_bf16 v[144:159], v[44:47], v[76:79], v[144:159]
    ds_read_b64 v[40:41], v10 offset:18432
    ds_read_b64 v[42:43], v11 offset:18432
    ds_read_b64 v[44:45], v12 offset:18432
    v_max3_f32 v13, v112, v113, v13
    v_max3_f32 v14, v114, v115, v14
    v_max3_f32 v13, v116, v117, v13
    v_max3_f32 v14, v118, v119, v14
    v_max3_f32 v13, v120, v121, v13
    v_max3_f32 v14, v122, v123, v14
    v_max3_f32 v13, v124, v125, v13
    v_max3_f32 v14, v126, v127, v14
    s_waitcnt lgkmcnt(6)
    v_mfma_f32_32x32x16_bf16 v[160:175], v[48:51], v[72:75], 0
    v_mfma_f32_32x32x16_bf16 v[160:175], v[52:55], v[76:79], v[160:175]
    ds_read_b64 v[48:49], v10 offset:21504
    ds_read_b64 v[50:51], v11 offset:21504
    ds_read_b64 v[52:53], v12 offset:21504
    v_max3_f32 v13, v128, v129, v13
    v_max3_f32 v14, v130, v131, v14
    v_max3_f32 v13, v132, v133, v13
    v_max3_f32 v14, v134, v135, v14
    v_max3_f32 v13, v136, v137, v13
    v_max3_f32 v14, v138, v139, v14
    v_max3_f32 v13, v140, v141, v13
    v_max3_f32 v14, v142, v143, v14
    s_waitcnt lgkmcnt(6)
    v_mfma_f32_32x32x16_bf16 v[176:191], v[32:35], v[72:75], 0
    v_mfma_f32_32x32x16_bf16 v[176:191], v[36:39], v[76:79], v[176:191]
    v_max3_f32 v13, v144, v145, v13
    v_max3_f32 v14, v146, v147, v14
    v_max3_f32 v13, v148, v149, v13
    v_max3_f32 v14, v150, v151, v14
    v_max3_f32 v13, v152, v153, v13
    v_max3_f32 v14, v154, v155, v14
    v_max3_f32 v13, v156, v157, v13
    v_max3_f32 v14, v158, v159, v14
    s_waitcnt lgkmcnt(3)
    v_mfma_f32_32x32x16_bf16 v[192:207], v[40:43], v[72:75], 0
    v_mfma_f32_32x32x16_bf16 v[192:207], v[44:47], v[76:79], v[192:207]
    v_max3_f32 v13, v160, v161, v13
    v_max3_f32 v14, v162, v163, v14
    v_max3_f32 v13, v164, v165, v13
    v_max3_f32 v14, v166, v167, v14
    v_max3_f32 v13, v168, v169, v13
    v_max3_f32 v14, v170, v171, v14
    v_max3_f32 v13, v172, v173, v13
    v_max3_f32 v14, v174, v175, v14
    s_waitcnt lgkmcnt(0)
    v_mfma_f32_32x32x16_bf16 v[208:223], v[48:51], v[72:75], 0
    v_mfma_f32_32x32x16_bf16 v[208:223], v[52:55], v[76:79], v[208:223]
    v_max3_f32 v13, v176, v177, v13
    v_max3_f32 v14, v178, v179, v14
    v_max3_f32 v13, v180, v181, v13
    v_max3_f32 v14, v182, v183, v14
    v_max3_f32 v13, v184, v185, v13
    v_max3_f32 v14, v186, v187, v14
    v_max3_f32 v13, v188, v189, v13
    v_max3_f32 v14, v190, v191, v14
    v_max3_f32 v13, v192, v193, v13
    v_max3_f32 v14, v194, v195, v14
    v_max3_f32 v13, v196, v197, v13
    v_max3_f32 v14, v198, v199, v14
    v_max3_f32 v13, v200, v201, v13
    v_max3_f32 v14, v202, v203, v14
    v_max3_f32 v13, v204, v205, v13
    v_max3_f32 v14, v206, v207, v14
    ds_read_b64_tr_b16 v[32:33], v28 offset:3072
    ds_read_b64_tr_b16 v[34:35], v29 offset:3072
    ds_read_b64_tr_b16 v[36:37], v30 offset:3072
    ds_read_b64_tr_b16 v[38:39], v31 offset:3072
    ds_read_b64_tr_b16 v[40:41], v28 offset:6144
    ds_read_b64_tr_b16 v[42:43], v29 offset:6144
    ds_read_b64_tr_b16 v[44:45], v30 offset:6144
    ds_read_b64_tr_b16 v[46:47], v31 offset:6144
    ds_read_b64_tr_b16 v[48:49], v28 offset:9216
    ds_read_b64_tr_b16 v[50:51], v29 offset:9216
    ds_read_b64_tr_b16 v[52:53], v30 offset:9216
    ds_read_b64_tr_b16 v[54:55], v31 offset:9216
    s_nop 4
    v_max3_f32 v13, v208, v209, v13
    v_max3_f32 v14, v210, v211, v14
    v_max3_f32 v13, v212, v213, v13
    v_max3_f32 v14, v214, v215, v14
    v_max3_f32 v13, v216, v217, v13
    v_max3_f32 v14, v218, v219, v14
    v_max3_f32 v13, v220, v221, v13
    v_max3_f32 v14, v222, v223, v14
    v_max_f32 v13, v13, v14
    v_mov_b32 v14, v13
    s_nop 1
    v_permlane32_swap_b32 v13, v14
    v_max_f32 v12, v13, v14
    v_cvt_pk_bf16_f32 v13, -v12, -v12
    v_and_b32 v13, 0xffff0000, v13
    v_sub_f32 v13, -v12, v13
    v_cvt_pk_bf16_f32 v26, -v12, v13
    s_nop 1
    v_mfma_f32_32x32x8bf16_1k v[112:127], v[56:57], v[26:27], v[112:127]
    v_mfma_f32_32x32x8bf16_1k v[128:143], v[56:57], v[26:27], v[128:143]
    s_nop 7
    s_nop 3
    v_exp_f32 v112, v112
    v_exp_f32 v113, v113
    v_exp_f32 v114, v114
    v_exp_f32 v115, v115
    v_exp_f32 v116, v116
    v_exp_f32 v117, v117
    v_mfma_f32_32x32x8bf16_1k v[144:159], v[56:57], v[26:27], v[144:159]
    v_exp_f32 v118, v118
    v_exp_f32 v119, v119
    v_cvt_pk_bf16_f32 v112, v112, v113
    v_cvt_pk_bf16_f32 v113, v114, v115
    v_cvt_pk_bf16_f32 v114, v116, v117
    v_cvt_pk_bf16_f32 v115, v118, v119
    v_exp_f32 v120, v120
    v_exp_f32 v121, v121
    s_waitcnt lgkmcnt(10)
    v_mfma_f32_32x32x16_bf16 v[80:95], v[32:35], v[112:115], 0
    ds_read_b64_tr_b16 v[32:33], v28 offset:12288
    ds_read_b64_tr_b16 v[34:35], v29 offset:12288
    v_exp_f32 v122, v122
    v_exp_f32 v123, v123
    v_exp_f32 v124, v124
    v_exp_f32 v125, v125
    v_exp_f32 v126, v126
    v_exp_f32 v127, v127
    v_cvt_pk_bf16_f32 v120, v120, v121
    v_cvt_pk_bf16_f32 v121, v122, v123
    v_cvt_pk_bf16_f32 v122, v124, v125
    v_cvt_pk_bf16_f32 v123, v126, v127
    v_exp_f32 v128, v128
    v_exp_f32 v129, v129
    s_waitcnt lgkmcnt(10)
    v_mfma_f32_32x32x16_bf16 v[80:95], v[36:39], v[120:123], v[80:95]
    ds_read_b64_tr_b16 v[36:37], v30 offset:12288
    ds_read_b64_tr_b16 v[38:39], v31 offset:12288
    v_exp_f32 v130, v130
    v_exp_f32 v131, v131
    v_exp_f32 v132, v132
    v_exp_f32 v133, v133
    v_mfma_f32_32x32x8bf16_1k v[160:175], v[56:57], v[26:27], v[160:175]
    v_exp_f32 v134, v134
    v_exp_f32 v135, v135
    v_cvt_pk_bf16_f32 v128, v128, v129
    v_cvt_pk_bf16_f32 v129, v130, v131
    v_cvt_pk_bf16_f32 v130, v132, v133
    v_cvt_pk_bf16_f32 v131, v134, v135
    v_exp_f32 v136, v136
    v_exp_f32 v137, v137
    s_waitcnt lgkmcnt(10)
    v_mfma_f32_32x32x16_bf16 v[80:95], v[40:43], v[128:131], v[80:95]
    ds_read_b64_tr_b16 v[40:41], v28 offset:15360
    ds_read_b64_tr_b16 v[42:43], v29 offset:15360
    v_exp_f32 v138, v138
    v_exp_f32 v139, v139
    v_exp_f32 v140, v140
    v_exp_f32 v141, v141
    v_exp_f32 v142, v142
    v_exp_f32 v143, v143
    v_cvt_pk_bf16_f32 v136, v136, v137
    v_cvt_pk_bf16_f32 v137, v138, v139
    v_cvt_pk_bf16_f32 v138, v140, v141
    v_cvt_pk_bf16_f32 v139, v142, v143
    v_exp_f32 v144, v144
    v_exp_f32 v145, v145
    s_waitcnt lgkmcnt(10)
    v_mfma_f32_32x32x16_bf16 v[80:95], v[44:47], v[136:139], v[80:95]
    ds_read_b64_tr_b16 v[44:45], v30 offset:15360
    ds_read_b64_tr_b16 v[46:47], v31 offset:15360
    v_exp_f32 v146, v146
    v_exp_f32 v147, v147
    v_exp_f32 v148, v148
    v_exp_f32 v149, v149
    v_mfma_f32_32x32x8bf16_1k v[176:191], v[56:57], v[26:27], v[176:191]
    v_exp_f32 v150, v150
    v_exp_f32 v151, v151
    v_cvt_pk_bf16_f32 v144, v144, v145
    v_cvt_pk_bf16_f32 v145, v146, v147
    v_cvt_pk_bf16_f32 v146, v148, v149
    v_cvt_pk_bf16_f32 v147, v150, v151
    v_exp_f32 v152, v152
    v_exp_f32 v153, v153
    s_waitcnt lgkmcnt(10)
    v_mfma_f32_32x32x16_bf16 v[80:95], v[48:51], v[144:147], v[80:95]
    ds_read_b64_tr_b16 v[48:49], v28 offset:18432
    ds_read_b64_tr_b16 v[50:51], v29 offset:18432
    v_exp_f32 v154, v154
    v_exp_f32 v155, v155
    v_exp_f32 v156, v156
    v_exp_f32 v157, v157
    v_exp_f32 v158, v158
    v_exp_f32 v159, v159
    v_cvt_pk_bf16_f32 v152, v152, v153
    v_cvt_pk_bf16_f32 v153, v154, v155
    v_cvt_pk_bf16_f32 v154, v156, v157
    v_cvt_pk_bf16_f32 v155, v158, v159
    v_exp_f32 v160, v160
    v_exp_f32 v161, v161
    s_waitcnt lgkmcnt(10)
    v_mfma_f32_32x32x16_bf16 v[80:95], v[52:55], v[152:155], v[80:95]
    ds_read_b64_tr_b16 v[52:53], v30 offset:18432
    ds_read_b64_tr_b16 v[54:55], v31 offset:18432
    v_exp_f32 v162, v162
    v_exp_f32 v163, v163
    v_exp_f32 v164, v164
    v_exp_f32 v165, v165
    v_mfma_f32_32x32x8bf16_1k v[192:207], v[56:57], v[26:27], v[192:207]
    v_exp_f32 v166, v166
    v_exp_f32 v167, v167
    v_cvt_pk_bf16_f32 v160, v160, v161
    v_cvt_pk_bf16_f32 v161, v162, v163
    v_cvt_pk_bf16_f32 v162, v164, v165
    v_cvt_pk_bf16_f32 v163, v166, v167
    v_exp_f32 v168, v168
    v_exp_f32 v169, v169
    s_waitcnt lgkmcnt(10)
    v_mfma_f32_32x32x16_bf16 v[80:95], v[32:35], v[160:163], v[80:95]
    ds_read_b64_tr_b16 v[32:33], v28 offset:21504
    ds_read_b64_tr_b16 v[34:35], v29 offset:21504
    v_exp_f32 v170, v170
    v_exp_f32 v171, v171
    v_exp_f32 v172, v172
    v_exp_f32 v173, v173
    v_exp_f32 v174, v174
    v_exp_f32 v175, v175
    v_cvt_pk_bf16_f32 v168, v168, v169
    v_cvt_pk_bf16_f32 v169, v170, v171
    v_cvt_pk_bf16_f32 v170, v172, v173
    v_cvt_pk_bf16_f32 v171, v174, v175
    v_exp_f32 v176, v176
    v_exp_f32 v177, v177
    s_waitcnt lgkmcnt(10)
    v_mfma_f32_32x32x16_bf16 v[80:95], v[36:39], v[168:171], v[80:95]
    ds_read_b64_tr_b16 v[36:37], v30 offset:21504
    ds_read_b64_tr_b16 v[38:39], v31 offset:21504
    v_exp_f32 v178, v178
    v_exp_f32 v179, v179
    v_exp_f32 v180, v180
    v_exp_f32 v181, v181
    v_mfma_f32_32x32x8bf16_1k v[208:223], v[56:57], v[26:27], v[208:223]
    v_exp_f32 v182, v182
    v_exp_f32 v183, v183
    v_cvt_pk_bf16_f32 v176, v176, v177
    v_cvt_pk_bf16_f32 v177, v178, v179
    v_cvt_pk_bf16_f32 v178, v180, v181
    v_cvt_pk_bf16_f32 v179, v182, v183
    v_exp_f32 v184, v184
    v_exp_f32 v185, v185
    s_waitcnt lgkmcnt(10)
    v_mfma_f32_32x32x16_bf16 v[80:95], v[40:43], v[176:179], v[80:95]
    ds_read_b64_tr_b16 v[40:41], v28 offset:24576
    ds_read_b64_tr_b16 v[42:43], v29 offset:24576
    v_exp_f32 v186, v186
    v_exp_f32 v187, v187
    v_exp_f32 v188, v188
    v_exp_f32 v189, v189
    v_exp_f32 v190, v190
    v_exp_f32 v191, v191
    v_cvt_pk_bf16_f32 v184, v184, v185
    v_cvt_pk_bf16_f32 v185, v186, v187
    v_cvt_pk_bf16_f32 v186, v188, v189
    v_cvt_pk_bf16_f32 v187, v190, v191
    v_exp_f32 v192, v192
    v_exp_f32 v193, v193
    s_waitcnt lgkmcnt(10)
    v_mfma_f32_32x32x16_bf16 v[80:95], v[44:47], v[184:187], v[80:95]
    ds_read_b64_tr_b16 v[44:45], v30 offset:24576
    ds_read_b64_tr_b16 v[46:47], v31 offset:24576
    v_exp_f32 v194, v194
    v_exp_f32 v195, v195
    v_exp_f32 v196, v196
    v_exp_f32 v197, v197
    v_mfma_f32_32x32x8bf16_1k v[224:239], v[56:57], v[26:27], v[224:239]
    v_exp_f32 v198, v198
    v_exp_f32 v199, v199
    v_cvt_pk_bf16_f32 v192, v192, v193
    v_cvt_pk_bf16_f32 v193, v194, v195
    v_cvt_pk_bf16_f32 v194, v196, v197
    v_cvt_pk_bf16_f32 v195, v198, v199
    v_exp_f32 v200, v200
    v_exp_f32 v201, v201
    s_waitcnt lgkmcnt(10)
    v_mfma_f32_32x32x16_bf16 v[80:95], v[48:51], v[192:195], v[80:95]
    ds_read_b64_tr_b16 v[48:49], v28 offset:0
    ds_read_b64_tr_b16 v[50:51], v29 offset:0
    v_exp_f32 v202, v202
    v_exp_f32 v203, v203
    v_exp_f32 v204, v204
    v_exp_f32 v205, v205
    v_exp_f32 v206, v206
    v_exp_f32 v207, v207
    v_cvt_pk_bf16_f32 v200, v200, v201
    v_cvt_pk_bf16_f32 v201, v202, v203
    v_cvt_pk_bf16_f32 v202, v204, v205
    v_cvt_pk_bf16_f32 v203, v206, v207
    v_exp_f32 v208, v208
    v_exp_f32 v209, v209
    s_waitcnt lgkmcnt(10)
    v_mfma_f32_32x32x16_bf16 v[80:95], v[52:55], v[200:203], v[80:95]
    ds_read_b64_tr_b16 v[52:53], v30 offset:0
    ds_read_b64_tr_b16 v[54:55], v31 offset:0
    v_exp_f32 v210, v210
    v_exp_f32 v211, v211
    v_exp_f32 v212, v212
    v_exp_f32 v213, v213
    v_exp_f32 v214, v214
    v_exp_f32 v215, v215
    v_cvt_pk_bf16_f32 v208, v208, v209
    v_cvt_pk_bf16_f32 v209, v210, v211
    v_cvt_pk_bf16_f32 v210, v212, v213
    v_cvt_pk_bf16_f32 v211, v214, v215
    v_exp_f32 v216, v216
    v_exp_f32 v217, v217
    s_waitcnt lgkmcnt(10)
    v_mfma_f32_32x32x16_bf16 v[80:95], v[32:35], v[208:211], v[80:95]
    v_exp_f32 v218, v218
    v_exp_f32 v219, v219
    v_exp_f32 v220, v220
    v_exp_f32 v221, v221
    v_exp_f32 v222, v222
    v_exp_f32 v223, v223
    v_cvt_pk_bf16_f32 v216, v216, v217
    v_cvt_pk_bf16_f32 v217, v218, v219
    v_cvt_pk_bf16_f32 v218, v220, v221
    v_cvt_pk_bf16_f32 v219, v222, v223
    v_exp_f32 v224, v224
    v_exp_f32 v225, v225
    s_waitcnt lgkmcnt(8)
    v_mfma_f32_32x32x16_bf16 v[80:95], v[36:39], v[216:219], v[80:95]
    v_exp_f32 v226, v226
    v_exp_f32 v227, v227
    v_exp_f32 v228, v228
    v_exp_f32 v229, v229
    v_exp_f32 v230, v230
    v_exp_f32 v231, v231
    v_cvt_pk_bf16_f32 v224, v224, v225
    v_cvt_pk_bf16_f32 v225, v226, v227
    v_cvt_pk_bf16_f32 v226, v228, v229
    v_cvt_pk_bf16_f32 v227, v230, v231
    v_and_b32 v228, v64, v224
    v_xor_b32 v96, v228, v224
    v_mov_b32 v224, v228
    v_and_b32 v229, v65, v225
    v_xor_b32 v97, v229, v225
    v_mov_b32 v225, v229
    v_and_b32 v230, v66, v226
    v_xor_b32 v98, v230, v226
    v_mov_b32 v226, v230
    v_and_b32 v231, v67, v227
    v_xor_b32 v99, v231, v227
    v_mov_b32 v227, v231
    v_exp_f32 v232, v232
    v_exp_f32 v233, v233
    s_waitcnt lgkmcnt(6)
    v_mfma_f32_32x32x16_bf16 v[80:95], v[40:43], v[224:227], v[80:95]
    v_exp_f32 v234, v234
    v_exp_f32 v235, v235
    v_exp_f32 v236, v236
    v_exp_f32 v237, v237
    v_exp_f32 v238, v238
    v_exp_f32 v239, v239
    v_cvt_pk_bf16_f32 v232, v232, v233
    v_cvt_pk_bf16_f32 v233, v234, v235
    v_cvt_pk_bf16_f32 v234, v236, v237
    v_cvt_pk_bf16_f32 v235, v238, v239
    v_and_b32 v236, v68, v232
    v_xor_b32 v104, v236, v232
    v_mov_b32 v232, v236
    v_and_b32 v237, v69, v233
    v_xor_b32 v105, v237, v233
    v_mov_b32 v233, v237
    v_and_b32 v238, v70, v234
    v_xor_b32 v106, v238, v234
    v_mov_b32 v234, v238
    v_and_b32 v239, v71, v235
    v_xor_b32 v107, v239, v235
    v_mov_b32 v235, v239
    s_nop 1
    s_waitcnt lgkmcnt(4)
    v_mfma_f32_32x32x16_bf16 v[80:95], v[44:47], v[232:235], v[80:95]
    s_waitcnt lgkmcnt(2)
    v_mfma_f32_32x32x16_bf16 v[80:95], v[48:51], v[96:99], v[80:95]
    s_waitcnt lgkmcnt(0)
    v_mfma_f32_32x32x16_bf16 v[80:95], v[52:55], v[104:107], v[80:95]
    s_nop 7
    s_nop 3
    v_rcp_f32 v14, v92
    s_nop 0
    v_mul_f32 v80, v80, v14
    v_mul_f32 v81, v81, v14
    v_mul_f32 v82, v82, v14
    v_mul_f32 v83, v83, v14
    v_cvt_pk_bf16_f32 v242, v80, v81
    v_cvt_pk_bf16_f32 v243, v82, v83
    v_mul_f32 v84, v84, v14
    v_mul_f32 v85, v85, v14
    v_mul_f32 v86, v86, v14
    v_mul_f32 v87, v87, v14
    v_cvt_pk_bf16_f32 v244, v84, v85
    v_cvt_pk_bf16_f32 v245, v86, v87
    v_mul_f32 v88, v88, v14
    v_mul_f32 v89, v89, v14
    v_mul_f32 v90, v90, v14
    v_mul_f32 v91, v91, v14
    v_cvt_pk_bf16_f32 v62, v88, v89
    v_cvt_pk_bf16_f32 v63, v90, v91
    v_permlane32_swap_b32 v242, v244
    v_permlane32_swap_b32 v243, v245
    v_permlane32_swap_b32 v246, v62
    v_permlane32_swap_b32 v247, v63
    v_permlane32_swap_b32 v240, v244
    v_permlane32_swap_b32 v241, v245
    buffer_store_dwordx4 v[240:243], v15, s[76:79], 0 offen offset:1024 sc1
    s_mov_b32 exec_lo, 0
    buffer_store_dwordx4 v[244:247], v15, s[76:79], 0 offen offset:1536 sc1
    s_mov_b32 exec_lo, -1
    v_mov_b32 v7, 40960
    s_setprio 0
    v_mov_b32 v6, 1
    s_mov_b64 exec, 1
    ds_add_u32 v7, v6 offset:40960
    s_mov_b64 exec, -1
    v_add_u32 v12, 0, v1
    v_lshrrev_b32 v13, 7, v12
    v_bfe_u32 v14, v12, 5, 2
    v_and_b32 v15, 15, v12
    v_lshl_add_u32 v14, v14, 4, v15
    v_mul_u32_u24 v14, 1280, v14
    v_lshl_add_u32 v14, v13, 5, v14
    v_and_b32 v13, 16, v12
    v_add_u32 v8, v13, v14
    buffer_load_dwordx4 v[16:19], v8, s[8:11], 0 offen
    v_add_u32 v12, 512, v1
    v_lshrrev_b32 v13, 7, v12
    v_bfe_u32 v14, v12, 5, 2
    v_and_b32 v15, 15, v12
    v_lshl_add_u32 v14, v14, 4, v15
    v_mul_u32_u24 v14, 1280, v14
    v_lshl_add_u32 v14, v13, 5, v14
    v_and_b32 v13, 16, v12
    v_add_u32 v9, v13, v14
    buffer_load_dwordx4 v[20:23], v9, s[8:11], 0 offen
    v_lshrrev_b32 v12, 4, v1
    v_lshlrev_b32 v12, 9, v12
    v_lshl_add_u32 v10, v15, 4, v12
    s_mul_i32 s33, s25, 20480
    v_lshl_add_u32 v11, v0, 4, s33
    s_waitcnt vmcnt(0)
RED_1002:
    s_waitcnt lgkmcnt(0)
    s_barrier
    v_add_u32 v11, 40960, v10
    ds_read_b128 v[32:35], v10 offset:0
    ds_read_b128 v[36:39], v10 offset:256
    ds_read_b128 v[40:43], v10 offset:20480
    ds_read_b128 v[44:47], v10 offset:20736
    ds_read_b128 v[48:51], v11 offset:0
    ds_read_b128 v[52:55], v11 offset:256
    ds_read_b128 v[56:59], v11 offset:20480
    ds_read_b128 v[60:63], v11 offset:20736
    s_waitcnt lgkmcnt(4)
    v_pk_add_f32 v[32:33], v[32:33], v[40:41]
    v_pk_add_f32 v[34:35], v[34:35], v[42:43]
    v_pk_add_f32 v[36:37], v[36:37], v[44:45]
    v_pk_add_f32 v[38:39], v[38:39], v[46:47]
    s_waitcnt lgkmcnt(2)
    v_pk_add_f32 v[32:33], v[32:33], v[48:49]
    v_pk_add_f32 v[34:35], v[34:35], v[50:51]
    v_pk_add_f32 v[36:37], v[36:37], v[52:53]
    v_pk_add_f32 v[38:39], v[38:39], v[54:55]
    s_waitcnt lgkmcnt(0)
    v_pk_add_f32 v[32:33], v[32:33], v[56:57]
    v_pk_add_f32 v[34:35], v[34:35], v[58:59]
    v_pk_add_f32 v[36:37], v[36:37], v[60:61]
    v_pk_add_f32 v[38:39], v[38:39], v[62:63]
    v_lshlrev_b32 v28, 16, v16
    v_and_b32 v29, 0xffff0000, v16
    v_pk_add_f32 v[32:33], v[32:33], v[28:29]
    v_cvt_pk_bf16_f32 v16, v32, v33
    v_lshlrev_b32 v28, 16, v17
    v_and_b32 v29, 0xffff0000, v17
    v_pk_add_f32 v[34:35], v[34:35], v[28:29]
    v_cvt_pk_bf16_f32 v17, v34, v35
    v_lshlrev_b32 v28, 16, v18
    v_and_b32 v29, 0xffff0000, v18
    v_pk_add_f32 v[36:37], v[36:37], v[28:29]
    v_cvt_pk_bf16_f32 v18, v36, v37
    v_lshlrev_b32 v28, 16, v19
    v_and_b32 v29, 0xffff0000, v19
    v_pk_add_f32 v[38:39], v[38:39], v[28:29]
    v_cvt_pk_bf16_f32 v19, v38, v39
    buffer_store_dwordx4 v[16:19], v8, s[12:15], 0 offen
    s_cmp_ge_u32 s24, 2
    s_cbranch_scc1 RED_DONE
    ds_read_b128 v[32:35], v10 offset:16384
    ds_read_b128 v[36:39], v10 offset:16640
    ds_read_b128 v[40:43], v10 offset:36864
    ds_read_b128 v[44:47], v10 offset:37120
    ds_read_b128 v[48:51], v11 offset:16384
    ds_read_b128 v[52:55], v11 offset:16640
    ds_read_b128 v[56:59], v11 offset:36864
    ds_read_b128 v[60:63], v11 offset:37120
    s_waitcnt lgkmcnt(4)
    v_pk_add_f32 v[32:33], v[32:33], v[40:41]
    v_pk_add_f32 v[34:35], v[34:35], v[42:43]
    v_pk_add_f32 v[36:37], v[36:37], v[44:45]
    v_pk_add_f32 v[38:39], v[38:39], v[46:47]
    s_waitcnt lgkmcnt(2)
    v_pk_add_f32 v[32:33], v[32:33], v[48:49]
    v_pk_add_f32 v[34:35], v[34:35], v[50:51]
    v_pk_add_f32 v[36:37], v[36:37], v[52:53]
    v_pk_add_f32 v[38:39], v[38:39], v[54:55]
    s_waitcnt lgkmcnt(0)
    v_pk_add_f32 v[32:33], v[32:33], v[56:57]
    v_pk_add_f32 v[34:35], v[34:35], v[58:59]
    v_pk_add_f32 v[36:37], v[36:37], v[60:61]
    v_pk_add_f32 v[38:39], v[38:39], v[62:63]
    v_lshlrev_b32 v28, 16, v20
    v_and_b32 v29, 0xffff0000, v20
    v_pk_add_f32 v[32:33], v[32:33], v[28:29]
    v_cvt_pk_bf16_f32 v20, v32, v33
    v_lshlrev_b32 v28, 16, v21
    v_and_b32 v29, 0xffff0000, v21
    v_pk_add_f32 v[34:35], v[34:35], v[28:29]
    v_cvt_pk_bf16_f32 v21, v34, v35
    v_lshlrev_b32 v28, 16, v22
    v_and_b32 v29, 0xffff0000, v22
    v_pk_add_f32 v[36:37], v[36:37], v[28:29]
    v_cvt_pk_bf16_f32 v22, v36, v37
    v_lshlrev_b32 v28, 16, v23
    v_and_b32 v29, 0xffff0000, v23
    v_pk_add_f32 v[38:39], v[38:39], v[28:29]
    v_cvt_pk_bf16_f32 v23, v38, v39
    buffer_store_dwordx4 v[20:23], v9, s[12:15], 0 offen
RED_DONE:
END_1:
    s_endpgm
CODE_END:
.section .rodata,"a"
.p2align 6
.amdhsa_kernel k1_kernel
  .amdhsa_next_free_vgpr 256
  .amdhsa_next_free_sgpr 102
  .amdhsa_accum_offset 256
  .amdhsa_group_segment_fixed_size 0
  .amdhsa_kernarg_size 80
  .amdhsa_user_sgpr_count 2
  .amdhsa_user_sgpr_kernarg_segment_ptr 1
  .amdhsa_system_sgpr_workgroup_id_x 1
.end_amdhsa_kernel
.p2align 6
.amdhsa_kernel parallel_sum__sliding_block__glu_gated_bilinear__prompt_kernel
  .amdhsa_next_free_vgpr 256
  .amdhsa_next_free_sgpr 102
  .amdhsa_accum_offset 256
  .amdhsa_group_segment_fixed_size 0
  .amdhsa_kernarg_size 80
  .amdhsa_user_sgpr_count 2
  .amdhsa_user_sgpr_kernarg_segment_ptr 1
  .amdhsa_system_sgpr_workgroup_id_x 1
.end_amdhsa_kernel
```
